```python
import torch

def _softmax(x, axis=-1):
    return torch.softmax(x, dim=axis)
def _gelu(x):
    return torch.nn.functional.gelu(x, approximate="tanh")
def _silu(x):
    return torch.nn.functional.silu(x)
def _sigmoid(x):
    return torch.sigmoid(x)
def _layernorm(x, axis=-1, eps=1e-5):
    m = x.mean(dim=axis, keepdim=True)
    v = x.var(dim=axis, keepdim=True, unbiased=False)
    return (x - m) / torch.sqrt(v + eps)
def _scatter_add(tgt, idx, src, axis=0):
    return tgt.clone().index_add_(axis, idx, src)
def _segment_sum(src, seg, n):
    out = torch.zeros((n,) + src.shape[1:], dtype=src.dtype)
    return out.index_add_(0, seg, src)
def _pad(x, pw):
    flat = tuple(v for pair in reversed(pw) for v in pair)
    return torch.nn.functional.pad(x, flat)

kernel_name = 'sequential_preLN__ssm_conv_s4d__glu_gated_bilinear__prompt'

def setup_inputs():

    _w = (lambda a: (lambda t: t.to(torch.bfloat16) if t.is_floating_point() else t)(torch.as_tensor(a)))
    def _A_setup():
        Bsz, L, D, N = 1, 2048, 640, 192
        return {
            "u": _w((lambda *s: torch.randn(*s, dtype=torch.bfloat16) * 0.05)(Bsz, L, D)),
            "log_A_real": _w((lambda *s: torch.randn(*s, dtype=torch.bfloat16) * 6.4)(D, N) * 0.5),
            "A_imag": _w((lambda *s: torch.randn(*s, dtype=torch.bfloat16) * 0.05)(D, N) * 3.14),
            "C_real": _w((lambda *s: torch.randn(*s, dtype=torch.bfloat16) * 0.05)(D, N) / N ** 0.5),
            "C_imag": _w((lambda *s: torch.randn(*s, dtype=torch.bfloat16) * 0.05)(D, N) / N ** 0.5),
            "log_dt": _w((lambda *s: torch.randn(*s, dtype=torch.bfloat16) * 0.05)(D) * 0.5 - 4.0),
            "D_skip": _w((lambda *s: torch.randn(*s, dtype=torch.bfloat16) * 0.05)(D)),
        }
    _A_in = _A_setup()

    def _B_setup():
        B, S, D, F = 1, 2048, 640, 1536
        return {
            "x": _w((lambda *s: torch.randn(*s, dtype=torch.bfloat16) * 0.05)(B, S, D)),
            "w_gate": _w((lambda *s: torch.randn(*s, dtype=torch.bfloat16) * 0.4)(D, F) * (D ** -0.5)),
            "w_up": _w((lambda *s: torch.randn(*s, dtype=torch.bfloat16) * 0.4)(D, F) * (D ** -0.5)),
            "w_down": _w((lambda *s: torch.randn(*s, dtype=torch.bfloat16) * 0.4)(F, D) * (F ** -0.5)),
        }
    _B_in = _B_setup()

    return {
        "A_u": _A_in["u"],
        "A_log_A_real": _A_in["log_A_real"],
        "A_A_imag": _A_in["A_imag"],
        "A_C_real": _A_in["C_real"],
        "A_C_imag": _A_in["C_imag"],
        "A_log_dt": _A_in["log_dt"],
        "A_D_skip": _A_in["D_skip"],
        "B_x": _B_in["x"],
        "B_w_gate": _B_in["w_gate"],
        "B_w_up": _B_in["w_up"],
        "B_w_down": _B_in["w_down"],
    }

def reference(A_u, A_log_A_real, A_A_imag, A_C_real, A_C_imag, A_log_dt, A_D_skip, B_x, B_w_gate, B_w_up, B_w_down):
    def _A_ref(u, log_A_real, A_imag, C_real, C_imag, log_dt, D_skip):
        L = u.shape[1]
        dt = torch.exp(log_dt)
        A = -torch.exp(log_A_real) + 1j * A_imag
        C = (C_real + 1j * C_imag) * dt[:, None]
        pos = (lambda x, dt: x.to(dt))(torch.arange(L), log_dt.dtype)
        P = torch.exp((A * dt[:, None])[:, :, None] * pos[None, None, :])
        K = 2.0 * torch.einsum("dn,dnl->dl", C, P).real
        L2 = 2 * L
        u_t = (lambda x, *d: x.permute(*d))(u, 0, 2, 1)
        Kf = (lambda x, *a, **k: torch.fft.rfft(x.float(), *a, **k))(K, L2)
        Uf = (lambda x, *a, **k: torch.fft.rfft(x.float(), *a, **k))(u_t, L2)
        y = (lambda x, *a, **k: torch.fft.irfft(x, *a, **k).to(torch.bfloat16))(Uf * Kf[None, :, :], L2)[:, :, :L]
        y = (lambda x, *d: x.permute(*d))(y, 0, 2, 1)
        return y + u * D_skip[None, None, :]

    def _B_ref(x, w_gate, w_up, w_down):
        g = torch.einsum("bsd,df->bsf", x, w_gate)
        u = torch.einsum("bsd,df->bsf", x, w_up)
        h = g * u
        return torch.einsum("bsf,fd->bsd", h, w_down)

    x = A_u
    h = x + _A_ref(_layernorm(x, axis=-1), A_log_A_real, A_A_imag, A_C_real, A_C_imag, A_log_dt, A_D_skip)
    h2 = h + _B_ref(_layernorm(h, axis=-1), B_w_gate, B_w_up, B_w_down)
    return h2
```

```asm
; @launch grid=(256,1,1) block=(256,1,1) lds=163840
.amdgcn_target "amdgcn-amd-amdhsa--gfx950"
.text
.globl sequential_preLN__ssm_conv_s4d__glu_gated_bilinear__prompt_kernel
.p2align 8
.type sequential_preLN__ssm_conv_s4d__glu_gated_bilinear__prompt_kernel,@function
sequential_preLN__ssm_conv_s4d__glu_gated_bilinear__prompt_kernel:
    s_cmp_ge_u32 s2, 256
    s_cbranch_scc1 L_end
    s_load_dwordx16 s[4:19], s[0:1], 0
    s_load_dwordx8 s[20:27], s[0:1], 64
    s_load_dwordx4 s[28:31], s[0:1], 96
    v_and_b32 v1, 63, v0
    v_lshrrev_b32 v2, 6, v0
    s_and_b32 s62, s2, 7
    v_readfirstlane_b32 s61, v2
    s_lshr_b32 s63, s2, 3
    v_lshlrev_b32 v225, 4, v1
    s_cmp_lt_u32 s63, 21
    s_cbranch_scc1 L_nopf
    s_getpc_b64 s[70:71]
L_pc:
    s_sub_u32 s70, s70, L_pc-sequential_preLN__ssm_conv_s4d__glu_gated_bilinear__prompt_kernel
    s_subb_u32 s71, s71, 0
    s_sub_u32 s65, 31, s63
    s_lshl_b32 s65, s65, 12
    v_lshl_add_u32 v2, v0, 4, s65
    v_min_u32 v2, L_code_end-sequential_preLN__ssm_conv_s4d__glu_gated_bilinear__prompt_kernel-16, v2
    v_mov_b32 v3, s71
    v_add_co_u32 v2, vcc, s70, v2
    s_nop 1
    v_addc_co_u32 v3, vcc, 0, v3, vcc
    global_load_dwordx4 v[70:73], v[2:3], off
L_nopf:
    s_cmp_lt_u32 s62, 8
    s_cselect_b32 s65, 20, 20
    s_cmp_lt_u32 s63, s65
    s_cbranch_scc0 L_pre
    s_lshl_b32 s65, s62, 4
    s_add_u32 s65, s65, s63
    s_mul_i32 s64, s62, 20
    s_add_u32 s64, s64, s63
    s_add_u32 s64, s64, 0
    s_cmp_lt_u32 s63, 0
    s_cselect_b32 s64, s65, s64
    s_cmp_lt_u32 s63, 16
    s_cselect_b32 s70, 0, 4
    s_cselect_b32 s71, 0, 2048
    s_sub_u32 s65, s65, s70
    s_lshl_b32 s65, s65, 4
    v_lshrrev_b32 v2, 4, v0
    v_add_u32 v2, s65, v2
    v_mul_u32_u24 v3, 1280, v2
    v_and_b32 v2, 2047, v2
    v_add_u32 v2, s71, v2
    v_and_b32 v4, 15, v0
    v_lshl_add_u32 v3, v4, 4, v3
    s_lshl_b32 s65, s64, 2
    s_add_u32 s65, s65, s61
    s_mul_i32 s65, s65, 384
    v_lshl_add_u32 v4, v1, 1, s65
    s_lshl_b32 s65, s64, 3
    v_mov_b32 v16, 0
    v_mov_b32 v17, 0
    v_mov_b32 v18, 0
    v_mov_b32 v19, 0
    v_mov_b32 v20, 0
    v_mov_b32 v21, 0
    v_mov_b32 v22, 0
    v_mov_b32 v23, 0
    v_mov_b32 v24, 0
    v_mov_b32 v25, 0
    v_mov_b32 v26, 0
    v_mov_b32 v27, 0
    s_mov_b32 s71, 0
    s_waitcnt lgkmcnt(0)
    s_mov_b32 s32, s4
    s_mov_b32 s33, s5
    s_mov_b32 s34, 2621440
    s_mov_b32 s35, 0x20000
    s_mov_b32 s40, s6
    s_mov_b32 s41, s7
    s_nop 0
    s_mov_b32 s42, 245760
    s_mov_b32 s43, 0x20000
    buffer_load_short_d16_hi v16, v4, s[40:43], 0 offen offset:0
    buffer_load_short_d16_hi v20, v4, s[40:43], 0 offen offset:128
    buffer_load_short_d16_hi v24, v4, s[40:43], 0 offen offset:256
    s_mov_b32 s44, s8
    s_mov_b32 s45, s9
    s_mov_b32 s46, 245760
    s_mov_b32 s47, 0x20000
    buffer_load_short_d16_hi v17, v4, s[44:47], 0 offen offset:0
    buffer_load_short_d16_hi v21, v4, s[44:47], 0 offen offset:128
    buffer_load_short_d16_hi v25, v4, s[44:47], 0 offen offset:256
    s_mov_b32 s48, s10
    s_mov_b32 s49, s11
    s_mov_b32 s50, 245760
    s_mov_b32 s51, 0x20000
    buffer_load_short_d16_hi v18, v4, s[48:51], 0 offen offset:0
    buffer_load_short_d16_hi v22, v4, s[48:51], 0 offen offset:128
    buffer_load_short_d16_hi v26, v4, s[48:51], 0 offen offset:256
    s_mov_b32 s52, s12
    s_mov_b32 s53, s13
    s_mov_b32 s54, 245760
    s_mov_b32 s55, 0x20000
    buffer_load_short_d16_hi v19, v4, s[52:55], 0 offen offset:0
    buffer_load_short_d16_hi v23, v4, s[52:55], 0 offen offset:128
    buffer_load_short_d16_hi v27, v4, s[52:55], 0 offen offset:256
    s_load_dword s60, s[30:31], s71
    s_load_dwordx2 s[66:67], s[14:15], s65
    s_load_dwordx2 s[96:97], s[16:17], s65
    buffer_load_dwordx4 v[46:49], v3, s[32:35], 0 offen offset:0
    buffer_load_dwordx4 v[50:53], v3, s[32:35], 0 offen offset:256
    buffer_load_dwordx4 v[54:57], v3, s[32:35], 0 offen offset:512
    buffer_load_dwordx4 v[58:61], v3, s[32:35], 0 offen offset:768
    buffer_load_dwordx4 v[62:65], v3, s[32:35], 0 offen offset:1024
    s_mov_b32 s36, s30
    s_mov_b32 s37, s31
    s_mov_b32 s38, 18874368
    s_mov_b32 s39, 0x20000
    s_mov_b32 s56, s26
    s_mov_b32 s57, s27
    s_mov_b32 s58, 2621440
    s_mov_b32 s59, 0x20000
    s_lshr_b32 s70, s62, 1
    s_lshl_b32 s98, s70, 2
    s_lshr_b32 s71, s63, 3
    s_add_u32 s98, s98, s71
    s_lshl_b32 s100, s70, 3
    s_lshr_b32 s71, s63, 2
    s_add_u32 s100, s100, s71
    s_and_b32 s70, s62, 1
    s_lshl_b32 s99, s70, 3
    s_and_b32 s71, s63, 7
    s_add_u32 s99, s99, s71
    s_lshl_b32 s101, s70, 2
    s_and_b32 s71, s63, 3
    s_add_u32 s101, s101, s71
    s_lshl_b32 s70, s98, 3
    s_lshl_b32 s71, s61, 1
    s_add_u32 s70, s70, s71
    s_mul_i32 s70, s70, 49152
    s_lshl_b32 s71, s99, 10
    s_add_u32 s70, s70, s71
    s_add_u32 s3, s70, 4194304
    v_add_u32 v227, 4096, v225
    v_min_u32 v226, 39, v1
    s_mul_i32 s70, s61, 40
    v_add_u32 v226, s70, v226
    v_lshlrev_b32 v226, 7, v226
    v_add_u32 v226, 36864, v226
    v_min_u32 v253, 47, v1
    v_lshlrev_b32 v253, 8, v253
    s_lshr_b32 s70, s101, 2
    s_lshl_b32 s70, s70, 7
    s_add_u32 s70, s70, 20480
    v_add_u32 v253, s70, v253
    v_and_b32 v254, 1, v1
    v_mul_u32_u24 v254, 48, v254
    v_min_u32 v255, 5, v1
    v_lshrrev_b32 v255, 1, v255
    v_add_u32 v254, v254, v255
    s_mul_i32 s70, s99, 3
    v_add_u32 v254, s70, v254
    v_lshlrev_b32 v254, 7, v254
    v_add_u32 v254, 4096, v254
    s_add_u32 s70, s61, 1
    s_and_b32 s70, s70, 3
    s_mul_i32 s70, s70, 49152
    v_add_u32 v228, s70, v225
    s_add_u32 s70, s61, 2
    s_and_b32 s70, s70, 3
    s_mul_i32 s70, s70, 49152
    v_add_u32 v229, s70, v225
    s_add_u32 s70, s61, 3
    s_and_b32 s70, s70, 3
    s_mul_i32 s70, s70, 49152
    v_add_u32 v230, s70, v225
    s_add_u32 s70, s61, 4
    s_and_b32 s70, s70, 3
    s_mul_i32 s70, s70, 49152
    v_add_u32 v231, s70, v225
    s_mul_i32 s69, s61, 5120
    s_mul_i32 s68, s99, 245760
    s_add_u32 s68, s68, 11534336
    s_add_u32 s68, s68, s69
    s_mul_i32 s30, s101, 245760
    s_add_u32 s30, s30, 15728640
    s_add_u32 s30, s30, s69
    s_lshl_b32 s28, s98, 10
    s_lshl_b32 s29, s61, 8
    s_add_u32 s28, s28, s29
    s_add_u32 s28, s28, 1048576
    s_mul_i32 s29, s100, 196608
    s_lshl_b32 s31, s61, 10
    s_add_u32 s29, s29, s31
    s_add_u32 s29, s29, 4194304
    s_add_u32 s31, s98, s99
    s_and_b32 s31, s31, 0
    s_add_u32 s31, s31, 0
    s_and_b32 s31, s31, 3
    s_mul_i32 s40, s31, 655360
    s_add_u32 s40, s40, s28
    s_mul_i32 s44, s31, 40960
    s_add_u32 s44, s44, s68
    s_mul_i32 s20, s31, 20480
    s_add_u32 s20, s20, s68
    s_add_u32 s31, s100, s101
    s_and_b32 s31, s31, 0
    s_add_u32 s31, s31, 0
    s_and_b32 s31, s31, 3
    s_mul_i32 s48, s31, 20480
    s_add_u32 s48, s48, s30
    s_lshl_b32 s52, s31, 12
    s_add_u32 s52, s52, s29
    s_add_u32 s31, s98, s99
    s_and_b32 s31, s31, 0
    s_add_u32 s31, s31, 1
    s_and_b32 s31, s31, 3
    s_mul_i32 s41, s31, 655360
    s_add_u32 s41, s41, s28
    s_mul_i32 s45, s31, 40960
    s_add_u32 s45, s45, s68
    s_mul_i32 s21, s31, 20480
    s_add_u32 s21, s21, s68
    s_add_u32 s31, s100, s101
    s_and_b32 s31, s31, 0
    s_add_u32 s31, s31, 1
    s_and_b32 s31, s31, 3
    s_mul_i32 s49, s31, 20480
    s_add_u32 s49, s49, s30
    s_lshl_b32 s53, s31, 12
    s_add_u32 s53, s53, s29
    s_add_u32 s31, s98, s99
    s_and_b32 s31, s31, 0
    s_add_u32 s31, s31, 2
    s_and_b32 s31, s31, 3
    s_mul_i32 s42, s31, 655360
    s_add_u32 s42, s42, s28
    s_mul_i32 s46, s31, 40960
    s_add_u32 s46, s46, s68
    s_mul_i32 s22, s31, 20480
    s_add_u32 s22, s22, s68
    s_add_u32 s31, s100, s101
    s_and_b32 s31, s31, 0
    s_add_u32 s31, s31, 2
    s_and_b32 s31, s31, 3
    s_mul_i32 s50, s31, 20480
    s_add_u32 s50, s50, s30
    s_lshl_b32 s54, s31, 12
    s_add_u32 s54, s54, s29
    s_add_u32 s31, s98, s99
    s_and_b32 s31, s31, 0
    s_add_u32 s31, s31, 3
    s_and_b32 s31, s31, 3
    s_mul_i32 s43, s31, 655360
    s_add_u32 s43, s43, s28
    s_mul_i32 s47, s31, 40960
    s_add_u32 s47, s47, s68
    s_mul_i32 s23, s31, 20480
    s_add_u32 s23, s23, s68
    s_add_u32 s31, s100, s101
    s_and_b32 s31, s31, 0
    s_add_u32 s31, s31, 3
    s_and_b32 s31, s31, 3
    s_mul_i32 s51, s31, 20480
    s_add_u32 s51, s51, s30
    s_lshl_b32 s55, s31, 12
    s_add_u32 s55, s55, s29
    v_lshlrev_b32 v251, 3, v2
    v_add_u32 v251, 131072, v251
    v_mul_u32_u24 v250, 10240, v0
    s_andn2_b32 s70, s65, 15
    v_add_u32 v250, s70, v250
    s_and_b32 s93, s65, 8
    s_lshl_b32 s70, s64, 14
    s_lshl_b32 s71, s61, 12
    s_add_u32 s70, s70, s71
    s_add_u32 s70, s70, 1048576
    v_add_u32 v224, s70, v225
    v_mov_b32 v28, -1
    v_mov_b32 v29, -1
    v_mov_b32 v30, -1
    v_mov_b32 v31, -1
    buffer_store_dwordx4 v[28:31], v224, s[36:39], 0 offen sc1
    buffer_store_dwordx4 v[28:31], v224, s[36:39], 0 offen offset:1024 sc1
    buffer_store_dwordx4 v[28:31], v224, s[36:39], 0 offen offset:2048 sc1
    buffer_store_dwordx4 v[28:31], v224, s[36:39], 0 offen offset:3072 sc1
    v_lshlrev_b32 v249, 6, v0
    v_add_u32 v249, 131072, v249
    s_mul_i32 s65, s61, 14416
    s_mov_b32 m0, s65
    v_and_b32 v5, 31, v1
    v_lshrrev_b32 v6, 5, v1
    v_mul_u32_u24 v123, 272, v5
    v_lshl_add_u32 v123, v6, 4, v123
    v_add_u32 v123, s65, v123
    v_mov_b32 v122, 0x3f80
    v_and_b32 v7, 7, v1
    v_lshl_add_u32 v232, v7, 2, s65
    v_lshlrev_b32 v7, 4, v5
    v_lshl_add_u32 v7, v6, 3, v7
    v_add_u32 v233, s65, v7
    v_cmp_eq_u32 vcc, 0, v6
    v_lshlrev_b32 v7, 3, v5
    v_add_u32 v7, 1024, v7
    v_lshlrev_b32 v8, 2, v5
    v_add_u32 v8, 1536, v8
    v_cndmask_b32 v7, v8, v7, vcc
    v_add_u32 v234, s65, v7
    v_mov_b32 v8, 128
    v_cndmask_b32 v8, v8, 4, vcc
    v_add_u32 v235, v234, v8
    v_lshlrev_b32 v7, 1, v5
    v_lshl_add_u32 v7, v6, 8, v7
    v_add_u32 v236, s65, v7
    v_mul_u32_u24 v7, 736, v6
    v_add_u32 v237, s65, v7
    v_lshl_add_u32 v238, v1, 3, s65
    v_lshl_add_u32 v239, v1, 2, s65
    v_add_u32 v239, 1024, v239
    s_mul_i32 s70, s61, 11008
    s_add_u32 s70, s70, 101376
    s_mul_i32 s71, s61, 4608
    s_add_u32 s71, s71, 145408
    v_lshl_add_u32 v240, v1, 3, s70
    v_lshl_add_u32 v241, v1, 4, s70
    v_add_u32 v252, s93, v241
    v_sub_u32 v242, 67, v1
    v_lshl_add_u32 v242, v242, 1, s70
    v_lshl_add_u32 v243, v1, 4, s71
    v_and_b32 v10, 15, v1
    v_lshrrev_b32 v11, 4, v1
    v_add_u32 v12, 1, v10
    v_and_b32 v13, 3, v12
    v_mul_u32_u24 v13, 2368, v13
    v_and_b32 v12, 28, v12
    v_lshl_add_u32 v13, v12, 1, v13
    v_lshl_add_u32 v13, v11, 4, v13
    v_add_u32 v244, s70, v13
    v_lshlrev_b32 v12, 5, v10
    v_sub_u32 v12, 480, v12
    v_lshl_add_u32 v12, v11, 4, v12
    v_add_u32 v245, s71, v12
    v_and_b32 v12, 7, v10
    v_lshrrev_b32 v13, 1, v11
    v_lshl_add_u32 v12, v13, 3, v12
    v_and_b32 v13, 1, v11
    v_lshl_add_u32 v12, v13, 4, v12
    v_lshrrev_b32 v13, 3, v10
    v_lshl_add_u32 v12, v13, 5, v12
    v_lshl_add_u32 v246, v12, 4, s70
    v_bfe_u32 v12, v0, 1, 3
    v_and_b32 v13, 1, v0
    v_lshl_add_u32 v12, v13, 3, v12
    v_lshrrev_b32 v13, 4, v0
    v_lshl_add_u32 v12, v13, 5, v12
    v_lshlrev_b32 v247, 4, v12
    v_add_u32 v247, 101376, v247
    v_lshlrev_b32 v248, 4, v0
    v_sub_u32 v248, 149488, v248
    v_mov_b32 v12, 0
    v_mov_b32 v13, 0
    v_mov_b32 v14, 0
    v_mov_b32 v15, 0
    ds_write_b128 v241, v[12:15] offset:9472
    s_mov_b32 exec_hi, 0
    ds_write_b128 v243, v[12:15] offset:4096
    ds_write_b128 v241, v[12:15] offset:10496
    s_mov_b64 exec, -1
    v_sub_u32 v12, 3, v10
    v_and_b32 v12, 3, v12
    v_mul_u32_u24 v13, 190, v12
    v_lshlrev_b32 v14, 2, v11
    v_sub_u32 v14, v14, v10
    v_lshl_add_u32 v13, v14, 1, v13
    v_add_u32 v13, 9510, v13
    v_add_u32 v243, s70, v13
    v_bfe_u32 v12, v1, 3, 2
    v_and_b32 v13, 7, v1
    v_mul_u32_u24 v14, 2368, v12
    v_lshl_add_u32 v2, v13, 3, v14
    v_add_u32 v2, s70, v2
    v_min_u32 v13, 4, v13
    v_sub_u32 v13, v13, v12
    v_lshl_add_u32 v3, v13, 1, v14
    v_add_u32 v3, s70, v3
    v_lshl_add_u32 v12, v11, 3, v10
    v_sub_u32 v12, 27, v12
    s_waitcnt lgkmcnt(0)
    s_add_u32 s60, s60, 0x9e3779b9
    s_cmp_lt_u32 s61, 2
    s_cselect_b32 s65, s66, s67
    s_and_b32 s70, s61, 1
    s_lshl_b32 s70, s70, 4
    s_lshr_b32 s65, s65, s70
    s_lshl_b32 s65, s65, 16
    s_lshl_b32 s94, s96, 16
    s_and_b32 s95, s96, 0xffff0000
    s_lshl_b32 s96, s97, 16
    s_and_b32 s97, s97, 0xffff0000
    v_mov_b32 v120, s65
    v_mul_f32 v120, 1069066811, v120
    v_exp_f32 v120, v120
    s_mov_b32 s92, 0x3f803f80
    v_cvt_pk_bf16_f32 v120, v120, v120
    v_and_b32 v120, 0xffff0000, v120
    v_add_f32 v121, v120, v120
    s_lshl_b32 s70, s64, 7
    s_add_u32 s70, s70, 36864
    v_mov_b32 v44, s70
    s_lshl_b32 s70, s98, 4
    s_add_u32 s70, s70, s99
    s_lshl_b32 s70, s70, 7
    s_add_u32 s70, s70, 65536
    v_mov_b32 v45, s70
    v_cmp_eq_u32 vcc, 0, v0
    v_mov_b32 v255, s60
    s_nop 0
    v_cndmask_b32 v44, -1, v44, vcc
    v_cndmask_b32 v45, -1, v45, vcc
    v_mov_b32 v34, 0x3f80
    v_mov_b32 v35, 0x3f800000
    v_subrev_u32 v13, 0, v12
    v_subrev_u32 v14, 1, v12
    v_cmp_gt_u32 vcc, 9, v13
    v_cmp_gt_u32 s[28:29], 9, v14
    s_nop 0
    v_cndmask_b32 v13, 0, v34, vcc
    v_cndmask_b32 v14, 0, v35, s[28:29]
    v_or_b32 v13, v13, v14
    v_accvgpr_write_b32 a248, v13
    v_subrev_u32 v13, 1, v12
    v_subrev_u32 v14, 2, v12
    v_cmp_gt_u32 vcc, 7, v13
    v_cmp_gt_u32 s[28:29], 7, v14
    s_nop 0
    v_cndmask_b32 v13, 0, v34, vcc
    v_cndmask_b32 v14, 0, v35, s[28:29]
    v_or_b32 v13, v13, v14
    v_accvgpr_write_b32 a252, v13
    v_subrev_u32 v13, 2, v12
    v_subrev_u32 v14, 3, v12
    v_cmp_gt_u32 vcc, 9, v13
    v_cmp_gt_u32 s[28:29], 9, v14
    s_nop 0
    v_cndmask_b32 v13, 0, v34, vcc
    v_cndmask_b32 v14, 0, v35, s[28:29]
    v_or_b32 v13, v13, v14
    v_accvgpr_write_b32 a249, v13
    v_subrev_u32 v13, 3, v12
    v_subrev_u32 v14, 4, v12
    v_cmp_gt_u32 vcc, 7, v13
    v_cmp_gt_u32 s[28:29], 7, v14
    s_nop 0
    v_cndmask_b32 v13, 0, v34, vcc
    v_cndmask_b32 v14, 0, v35, s[28:29]
    v_or_b32 v13, v13, v14
    v_accvgpr_write_b32 a253, v13
    v_subrev_u32 v13, 4, v12
    v_subrev_u32 v14, 5, v12
    v_cmp_gt_u32 vcc, 9, v13
    v_cmp_gt_u32 s[28:29], 9, v14
    s_nop 0
    v_cndmask_b32 v13, 0, v34, vcc
    v_cndmask_b32 v14, 0, v35, s[28:29]
    v_or_b32 v13, v13, v14
    v_accvgpr_write_b32 a250, v13
    v_subrev_u32 v13, 5, v12
    v_subrev_u32 v14, 6, v12
    v_cmp_gt_u32 vcc, 7, v13
    v_cmp_gt_u32 s[28:29], 7, v14
    s_nop 0
    v_cndmask_b32 v13, 0, v34, vcc
    v_cndmask_b32 v14, 0, v35, s[28:29]
    v_or_b32 v13, v13, v14
    v_accvgpr_write_b32 a254, v13
    v_subrev_u32 v13, 6, v12
    v_subrev_u32 v14, 7, v12
    v_cmp_gt_u32 vcc, 9, v13
    v_cmp_gt_u32 s[28:29], 9, v14
    s_nop 0
    v_cndmask_b32 v13, 0, v34, vcc
    v_cndmask_b32 v14, 0, v35, s[28:29]
    v_or_b32 v13, v13, v14
    v_accvgpr_write_b32 a251, v13
    v_subrev_u32 v13, 7, v12
    v_subrev_u32 v14, 8, v12
    v_cmp_gt_u32 vcc, 7, v13
    v_cmp_gt_u32 s[28:29], 7, v14
    s_nop 0
    v_cndmask_b32 v13, 0, v34, vcc
    v_cndmask_b32 v14, 0, v35, s[28:29]
    v_or_b32 v13, v13, v14
    v_accvgpr_write_b32 a255, v13
    s_mov_b32 s29, 0
    s_mul_i32 s65, s61, 14416
    s_mul_i32 s66, s61, 11008
    s_add_u32 s66, s66, 101376
    s_and_b32 s67, s63, 7
    v_mov_b32 v142, 0
    v_mov_b32 v143, 0
    v_mov_b32 v144, 0
    v_mov_b32 v145, 0
    v_mov_b32 v146, 0
    v_mov_b32 v147, 0
    v_mov_b32 v148, 0
    v_mov_b32 v149, 0
    v_mov_b32 v150, 0
    v_mov_b32 v151, 0
    v_mov_b32 v152, 0
    v_mov_b32 v153, 0
    v_mov_b32 v154, 0
    v_mov_b32 v155, 0
    v_mov_b32 v156, 0
    v_mov_b32 v157, 0
    s_waitcnt vmcnt(9)
    v_mul_f32 v10, 1069066811, v16
    v_mul_f32 v11, v17, v120
    v_exp_f32 v10, v10
    v_mul_f32 v11, 1042479491, v11
    v_mul_f32 v92, v18, v121
    v_cvt_pk_bf16_f32 v10, v10, v10
    v_mul_f32 v93, v19, v121
    v_and_b32 v10, 0xffff0000, v10
    v_mul_f32 v10, v10, v120
    v_mul_f32 v10, 3216550459, v10
    v_fract_f32 v13, v11
    v_exp_f32 v12, v10
    v_cos_f32 v14, v13
    v_sin_f32 v15, v13
    v_mul_f32 v6, 0x41000000, v10
    v_mul_f32 v7, 0x41000000, v11
    v_mul_f32 v78, v12, v14
    v_mul_f32 v79, v12, v15
    v_exp_f32 v6, v6
    v_fract_f32 v7, v7
    v_mul_f32 v12, 0x43800000, v10
    v_cos_f32 v8, v7
    v_sin_f32 v9, v7
    v_mul_f32 v13, 0x43800000, v11
    v_exp_f32 v12, v12
    v_fract_f32 v13, v13
    v_mul_f32 v80, v6, v8
    v_mul_f32 v81, v6, v9
    v_cos_f32 v14, v13
    v_sin_f32 v15, v13
    v_mov_b32 v16, v20
    v_mul_f32 v82, v12, v14
    v_mul_f32 v83, v12, v15
    v_mov_b32 v17, v21
    v_mov_b32 v18, v22
    v_mov_b32 v19, v23
    v_mov_b32 v20, v24
    v_mov_b32 v21, v25
    v_mov_b32 v22, v26
    v_mov_b32 v23, v27
    s_waitcnt vmcnt(4)
    v_dot2_f32_bf16 v14, v46, s92, 0
    v_dot2_f32_bf16 v15, v46, v46, 0
    v_dot2_f32_bf16 v14, v47, s92, v14
    v_dot2_f32_bf16 v15, v47, v47, v15
    v_dot2_f32_bf16 v14, v48, s92, v14
    v_dot2_f32_bf16 v15, v48, v48, v15
    v_dot2_f32_bf16 v14, v49, s92, v14
    v_dot2_f32_bf16 v15, v49, v49, v15
    v_dot2_f32_bf16 v14, v50, s92, v14
    v_dot2_f32_bf16 v15, v50, v50, v15
    v_dot2_f32_bf16 v14, v51, s92, v14
    v_dot2_f32_bf16 v15, v51, v51, v15
    v_dot2_f32_bf16 v14, v52, s92, v14
    v_dot2_f32_bf16 v15, v52, v52, v15
    v_dot2_f32_bf16 v14, v53, s92, v14
    v_dot2_f32_bf16 v15, v53, v53, v15
    v_dot2_f32_bf16 v14, v54, s92, v14
    v_dot2_f32_bf16 v15, v54, v54, v15
    v_dot2_f32_bf16 v14, v55, s92, v14
    v_dot2_f32_bf16 v15, v55, v55, v15
    v_dot2_f32_bf16 v14, v56, s92, v14
    v_dot2_f32_bf16 v15, v56, v56, v15
    v_dot2_f32_bf16 v14, v57, s92, v14
    v_dot2_f32_bf16 v15, v57, v57, v15
    v_dot2_f32_bf16 v14, v58, s92, v14
    v_dot2_f32_bf16 v15, v58, v58, v15
    v_dot2_f32_bf16 v14, v59, s92, v14
    v_dot2_f32_bf16 v15, v59, v59, v15
    v_dot2_f32_bf16 v14, v60, s92, v14
    v_dot2_f32_bf16 v15, v60, v60, v15
    v_dot2_f32_bf16 v14, v61, s92, v14
    v_dot2_f32_bf16 v15, v61, v61, v15
    v_dot2_f32_bf16 v14, v62, s92, v14
    v_dot2_f32_bf16 v15, v62, v62, v15
    v_dot2_f32_bf16 v14, v63, s92, v14
    v_dot2_f32_bf16 v15, v63, v63, v15
    v_dot2_f32_bf16 v14, v64, s92, v14
    v_dot2_f32_bf16 v15, v64, v64, v15
    v_dot2_f32_bf16 v14, v65, s92, v14
    v_dot2_f32_bf16 v15, v65, v65, v15
    s_nop 1
    v_add_f32_dpp v14, v14, v14 row_shr:1 row_mask:0xf bank_mask:0xf bound_ctrl:1
    v_add_f32_dpp v15, v15, v15 row_shr:1 row_mask:0xf bank_mask:0xf bound_ctrl:1
    s_nop 0
    v_add_f32_dpp v14, v14, v14 row_shr:2 row_mask:0xf bank_mask:0xf bound_ctrl:1
    v_add_f32_dpp v15, v15, v15 row_shr:2 row_mask:0xf bank_mask:0xf bound_ctrl:1
    s_nop 0
    v_add_f32_dpp v14, v14, v14 row_shr:4 row_mask:0xf bank_mask:0xf bound_ctrl:1
    v_add_f32_dpp v15, v15, v15 row_shr:4 row_mask:0xf bank_mask:0xf bound_ctrl:1
    s_nop 0
    v_add_f32_dpp v14, v14, v14 row_shr:8 row_mask:0xf bank_mask:0xf bound_ctrl:1
    v_add_f32_dpp v15, v15, v15 row_shr:8 row_mask:0xf bank_mask:0xf bound_ctrl:1
    v_mul_f32 v14, 0x3acccccd, v14
    v_mul_f32 v15, 0x3acccccd, v15
    v_fma_f32 v15, -v14, v14, v15
    v_max_f32_e64 v15, 0, v15
    v_cvt_pk_bf16_f32 v5, v15, v15
    v_and_b32 v5, 0xffff0000, v5
    v_add_f32 v5, 0x3727c5ac, v5
    v_cvt_pk_bf16_f32 v5, v5, v5
    v_and_b32 v5, 0xffff0000, v5
    v_sqrt_f32 v5, v5
    s_nop 0
    v_cvt_pk_bf16_f32 v4, v5, v14
    v_mov_b32 v5, s60
    s_mov_b32 exec_lo, 0x80008000
    s_mov_b32 exec_hi, 0x80008000
    buffer_store_dwordx2 v[4:5], v251, s[36:39], 0 offen sc1
    s_mov_b64 exec, -1
    s_mov_b32 s71, 0
L_kgen:
    s_nop 0
    v_cvt_pk_bf16_f32 v104, v92, -v93
    v_pk_mul_f32 v[88:89], v[92:93], v[78:79] op_sel:[0,0] op_sel_hi:[0,1]
    v_pk_fma_f32 v[84:85], v[92:93], v[78:79], v[88:89] op_sel:[1,1,0] op_sel_hi:[1,0,1] neg_lo:[0,1,0]
    v_cvt_pk_bf16_f32 v105, v84, -v85
    v_pk_mul_f32 v[88:89], v[84:85], v[78:79] op_sel:[0,0] op_sel_hi:[0,1]
    v_pk_fma_f32 v[94:95], v[84:85], v[78:79], v[88:89] op_sel:[1,1,0] op_sel_hi:[1,0,1] neg_lo:[0,1,0]
    v_cvt_pk_bf16_f32 v106, v94, -v95
    v_pk_mul_f32 v[88:89], v[94:95], v[78:79] op_sel:[0,0] op_sel_hi:[0,1]
    v_pk_fma_f32 v[84:85], v[94:95], v[78:79], v[88:89] op_sel:[1,1,0] op_sel_hi:[1,0,1] neg_lo:[0,1,0]
    v_cvt_pk_bf16_f32 v107, v84, -v85
    v_pk_mul_f32 v[88:89], v[84:85], v[78:79] op_sel:[0,0] op_sel_hi:[0,1]
    v_pk_fma_f32 v[96:97], v[84:85], v[78:79], v[88:89] op_sel:[1,1,0] op_sel_hi:[1,0,1] neg_lo:[0,1,0]
    v_cvt_pk_bf16_f32 v108, v96, -v97
    v_pk_mul_f32 v[88:89], v[96:97], v[78:79] op_sel:[0,0] op_sel_hi:[0,1]
    v_pk_fma_f32 v[84:85], v[96:97], v[78:79], v[88:89] op_sel:[1,1,0] op_sel_hi:[1,0,1] neg_lo:[0,1,0]
    v_cvt_pk_bf16_f32 v109, v84, -v85
    v_pk_mul_f32 v[88:89], v[84:85], v[78:79] op_sel:[0,0] op_sel_hi:[0,1]
    v_pk_fma_f32 v[98:99], v[84:85], v[78:79], v[88:89] op_sel:[1,1,0] op_sel_hi:[1,0,1] neg_lo:[0,1,0]
    v_cvt_pk_bf16_f32 v110, v98, -v99
    ds_write_addtid_b32 v122 offset:5712
    ds_write_addtid_b32 v104 offset:0
    ds_write_addtid_b32 v105 offset:272
    ds_write_addtid_b32 v106 offset:544
    ds_write_addtid_b32 v107 offset:816
    ds_write_addtid_b32 v108 offset:1088
    ds_write_addtid_b32 v109 offset:1360
    ds_write_addtid_b32 v110 offset:1632
    s_mul_i32 s93, s67, 1280
    s_lshl_b32 s28, s67, 10
    s_add_u32 m0, s66, s28
    s_add_u32 s93, s93, s29
    s_add_u32 s67, s67, 1
    buffer_load_dwordx4 v250, s[32:35], s93 offen lds
    s_mov_b32 m0, s65
    s_and_b32 s67, s67, 7
    v_pk_mul_f32 v[88:89], v[98:99], v[78:79] op_sel:[0,0] op_sel_hi:[0,1]
    v_pk_fma_f32 v[84:85], v[98:99], v[78:79], v[88:89] op_sel:[1,1,0] op_sel_hi:[1,0,1] neg_lo:[0,1,0]
    v_cvt_pk_bf16_f32 v111, v84, -v85
    v_pk_mul_f32 v[88:89], v[92:93], v[82:83] op_sel:[0,0] op_sel_hi:[0,1]
    v_pk_fma_f32 v[100:101], v[92:93], v[82:83], v[88:89] op_sel:[1,1,0] op_sel_hi:[1,0,1] neg_lo:[0,1,0]
    v_cvt_pk_bf16_f32 v112, v100, -v101
    v_pk_mul_f32 v[88:89], v[94:95], v[82:83] op_sel:[0,0] op_sel_hi:[0,1]
    v_pk_fma_f32 v[84:85], v[94:95], v[82:83], v[88:89] op_sel:[1,1,0] op_sel_hi:[1,0,1] neg_lo:[0,1,0]
    v_cvt_pk_bf16_f32 v113, v84, -v85
    v_pk_mul_f32 v[88:89], v[96:97], v[82:83] op_sel:[0,0] op_sel_hi:[0,1]
    v_pk_fma_f32 v[102:103], v[96:97], v[82:83], v[88:89] op_sel:[1,1,0] op_sel_hi:[1,0,1] neg_lo:[0,1,0]
    v_cvt_pk_bf16_f32 v114, v102, -v103
    v_pk_mul_f32 v[88:89], v[98:99], v[82:83] op_sel:[0,0] op_sel_hi:[0,1]
    v_pk_fma_f32 v[84:85], v[98:99], v[82:83], v[88:89] op_sel:[1,1,0] op_sel_hi:[1,0,1] neg_lo:[0,1,0]
    v_cvt_pk_bf16_f32 v115, v84, -v85
    v_pk_mul_f32 v[88:89], v[100:101], v[82:83] op_sel:[0,0] op_sel_hi:[0,1]
    v_pk_fma_f32 v[100:101], v[100:101], v[82:83], v[88:89] op_sel:[1,1,0] op_sel_hi:[1,0,1] neg_lo:[0,1,0]
    v_cvt_pk_bf16_f32 v116, v100, -v101
    v_pk_mul_f32 v[88:89], v[102:103], v[82:83] op_sel:[0,0] op_sel_hi:[0,1]
    v_pk_fma_f32 v[102:103], v[102:103], v[82:83], v[88:89] op_sel:[1,1,0] op_sel_hi:[1,0,1] neg_lo:[0,1,0]
    v_cvt_pk_bf16_f32 v117, v102, -v103
    v_pk_mul_f32 v[88:89], v[100:101], v[82:83] op_sel:[0,0] op_sel_hi:[0,1]
    v_pk_fma_f32 v[100:101], v[100:101], v[82:83], v[88:89] op_sel:[1,1,0] op_sel_hi:[1,0,1] neg_lo:[0,1,0]
    v_cvt_pk_bf16_f32 v118, v100, -v101
    ds_write_addtid_b32 v111 offset:1904
    ds_write_addtid_b32 v112 offset:2176
    ds_write_addtid_b32 v113 offset:2448
    ds_write_addtid_b32 v114 offset:2720
    ds_write_addtid_b32 v115 offset:2992
    ds_write_addtid_b32 v116 offset:3264
    ds_write_addtid_b32 v117 offset:3536
    ds_write_addtid_b32 v118 offset:3808
    v_pk_mul_f32 v[88:89], v[102:103], v[82:83] op_sel:[0,0] op_sel_hi:[0,1]
    v_pk_fma_f32 v[102:103], v[102:103], v[82:83], v[88:89] op_sel:[1,1,0] op_sel_hi:[1,0,1] neg_lo:[0,1,0]
    v_cvt_pk_bf16_f32 v119, v102, -v103
    v_pk_mul_f32 v[88:89], v[100:101], v[82:83] op_sel:[0,0] op_sel_hi:[0,1]
    v_pk_fma_f32 v[100:101], v[100:101], v[82:83], v[88:89] op_sel:[1,1,0] op_sel_hi:[1,0,1] neg_lo:[0,1,0]
    v_cvt_pk_bf16_f32 v104, v100, -v101
    v_pk_mul_f32 v[88:89], v[100:101], v[82:83] op_sel:[0,0] op_sel_hi:[0,1]
    v_pk_fma_f32 v[100:101], v[100:101], v[82:83], v[88:89] op_sel:[1,1,0] op_sel_hi:[1,0,1] neg_lo:[0,1,0]
    v_cvt_pk_bf16_f32 v105, v100, -v101
    v_pk_mul_f32 v[88:89], v[100:101], v[82:83] op_sel:[0,0] op_sel_hi:[0,1]
    v_pk_fma_f32 v[100:101], v[100:101], v[82:83], v[88:89] op_sel:[1,1,0] op_sel_hi:[1,0,1] neg_lo:[0,1,0]
    v_cvt_pk_bf16_f32 v106, v100, -v101
    v_pk_mul_f32 v[88:89], v[100:101], v[82:83] op_sel:[0,0] op_sel_hi:[0,1]
    v_pk_fma_f32 v[100:101], v[100:101], v[82:83], v[88:89] op_sel:[1,1,0] op_sel_hi:[1,0,1] neg_lo:[0,1,0]
    v_cvt_pk_bf16_f32 v107, v100, -v101
    v_pk_mul_f32 v[88:89], v[100:101], v[82:83] op_sel:[0,0] op_sel_hi:[0,1]
    v_pk_fma_f32 v[100:101], v[100:101], v[82:83], v[88:89] op_sel:[1,1,0] op_sel_hi:[1,0,1] neg_lo:[0,1,0]
    v_cvt_pk_bf16_f32 v108, v100, -v101
    v_cvt_pk_bf16_f32 v109, v80, v81
    v_pk_mul_f32 v[88:89], v[80:81], v[80:81] op_sel:[0,0] op_sel_hi:[0,1]
    v_pk_fma_f32 v[86:87], v[80:81], v[80:81], v[88:89] op_sel:[1,1,0] op_sel_hi:[1,0,1] neg_lo:[0,1,0]
    v_cvt_pk_bf16_f32 v110, v86, v87
    ds_write_addtid_b32 v119 offset:4080
    ds_write_addtid_b32 v104 offset:4352
    ds_write_addtid_b32 v105 offset:4624
    ds_write_addtid_b32 v106 offset:4896
    ds_write_addtid_b32 v107 offset:5168
    ds_write_addtid_b32 v108 offset:5440
    ds_write_addtid_b32 v109 offset:5984
    ds_write_addtid_b32 v110 offset:6256
    s_mul_i32 s93, s67, 1280
    s_lshl_b32 s28, s67, 10
    s_add_u32 m0, s66, s28
    s_add_u32 s93, s93, s29
    s_add_u32 s67, s67, 1
    buffer_load_dwordx4 v250, s[32:35], s93 offen lds
    s_mov_b32 m0, s65
    s_and_b32 s67, s67, 7
    v_pk_mul_f32 v[88:89], v[86:87], v[80:81] op_sel:[0,0] op_sel_hi:[0,1]
    v_pk_fma_f32 v[86:87], v[86:87], v[80:81], v[88:89] op_sel:[1,1,0] op_sel_hi:[1,0,1] neg_lo:[0,1,0]
    v_cvt_pk_bf16_f32 v111, v86, v87
    v_pk_mul_f32 v[88:89], v[86:87], v[80:81] op_sel:[0,0] op_sel_hi:[0,1]
    v_pk_fma_f32 v[86:87], v[86:87], v[80:81], v[88:89] op_sel:[1,1,0] op_sel_hi:[1,0,1] neg_lo:[0,1,0]
    v_cvt_pk_bf16_f32 v112, v86, v87
    v_pk_mul_f32 v[88:89], v[86:87], v[80:81] op_sel:[0,0] op_sel_hi:[0,1]
    v_pk_fma_f32 v[86:87], v[86:87], v[80:81], v[88:89] op_sel:[1,1,0] op_sel_hi:[1,0,1] neg_lo:[0,1,0]
    v_cvt_pk_bf16_f32 v113, v86, v87
    v_pk_mul_f32 v[88:89], v[86:87], v[80:81] op_sel:[0,0] op_sel_hi:[0,1]
    v_pk_fma_f32 v[86:87], v[86:87], v[80:81], v[88:89] op_sel:[1,1,0] op_sel_hi:[1,0,1] neg_lo:[0,1,0]
    v_cvt_pk_bf16_f32 v114, v86, v87
    v_pk_mul_f32 v[88:89], v[86:87], v[80:81] op_sel:[0,0] op_sel_hi:[0,1]
    v_pk_fma_f32 v[86:87], v[86:87], v[80:81], v[88:89] op_sel:[1,1,0] op_sel_hi:[1,0,1] neg_lo:[0,1,0]
    v_cvt_pk_bf16_f32 v115, v86, v87
    v_pk_mul_f32 v[88:89], v[86:87], v[80:81] op_sel:[0,0] op_sel_hi:[0,1]
    v_pk_fma_f32 v[86:87], v[86:87], v[80:81], v[88:89] op_sel:[1,1,0] op_sel_hi:[1,0,1] neg_lo:[0,1,0]
    v_cvt_pk_bf16_f32 v116, v86, v87
    v_pk_mul_f32 v[88:89], v[86:87], v[80:81] op_sel:[0,0] op_sel_hi:[0,1]
    v_pk_fma_f32 v[86:87], v[86:87], v[80:81], v[88:89] op_sel:[1,1,0] op_sel_hi:[1,0,1] neg_lo:[0,1,0]
    v_cvt_pk_bf16_f32 v117, v86, v87
    v_pk_mul_f32 v[88:89], v[86:87], v[80:81] op_sel:[0,0] op_sel_hi:[0,1]
    v_pk_fma_f32 v[86:87], v[86:87], v[80:81], v[88:89] op_sel:[1,1,0] op_sel_hi:[1,0,1] neg_lo:[0,1,0]
    v_cvt_pk_bf16_f32 v118, v86, v87
    ds_write_addtid_b32 v111 offset:6528
    ds_write_addtid_b32 v112 offset:6800
    ds_write_addtid_b32 v113 offset:7072
    ds_write_addtid_b32 v114 offset:7344
    ds_write_addtid_b32 v115 offset:7616
    ds_write_addtid_b32 v116 offset:7888
    ds_write_addtid_b32 v117 offset:8160
    ds_write_addtid_b32 v118 offset:8432
    ds_read_b128 a[0:3], v123 offset:0
    ds_read_b128 a[8:11], v123 offset:32
    ds_read_b128 a[16:19], v123 offset:64
    ds_read_b128 a[24:27], v123 offset:96
    ds_read_b128 a[32:35], v123 offset:128
    ds_read_b128 a[40:43], v123 offset:160
    ds_read_b128 a[48:51], v123 offset:192
    ds_read_b128 a[56:59], v123 offset:224
    v_pk_mul_f32 v[88:89], v[86:87], v[80:81] op_sel:[0,0] op_sel_hi:[0,1]
    v_pk_fma_f32 v[86:87], v[86:87], v[80:81], v[88:89] op_sel:[1,1,0] op_sel_hi:[1,0,1] neg_lo:[0,1,0]
    v_cvt_pk_bf16_f32 v119, v86, v87
    v_pk_mul_f32 v[88:89], v[86:87], v[80:81] op_sel:[0,0] op_sel_hi:[0,1]
    v_pk_fma_f32 v[86:87], v[86:87], v[80:81], v[88:89] op_sel:[1,1,0] op_sel_hi:[1,0,1] neg_lo:[0,1,0]
    v_cvt_pk_bf16_f32 v104, v86, v87
    v_pk_mul_f32 v[88:89], v[86:87], v[80:81] op_sel:[0,0] op_sel_hi:[0,1]
    v_pk_fma_f32 v[86:87], v[86:87], v[80:81], v[88:89] op_sel:[1,1,0] op_sel_hi:[1,0,1] neg_lo:[0,1,0]
    v_cvt_pk_bf16_f32 v105, v86, v87
    v_pk_mul_f32 v[88:89], v[86:87], v[80:81] op_sel:[0,0] op_sel_hi:[0,1]
    v_pk_fma_f32 v[86:87], v[86:87], v[80:81], v[88:89] op_sel:[1,1,0] op_sel_hi:[1,0,1] neg_lo:[0,1,0]
    v_cvt_pk_bf16_f32 v106, v86, v87
    v_pk_mul_f32 v[88:89], v[86:87], v[80:81] op_sel:[0,0] op_sel_hi:[0,1]
    v_pk_fma_f32 v[86:87], v[86:87], v[80:81], v[88:89] op_sel:[1,1,0] op_sel_hi:[1,0,1] neg_lo:[0,1,0]
    v_cvt_pk_bf16_f32 v107, v86, v87
    v_pk_mul_f32 v[88:89], v[86:87], v[80:81] op_sel:[0,0] op_sel_hi:[0,1]
    v_pk_fma_f32 v[86:87], v[86:87], v[80:81], v[88:89] op_sel:[1,1,0] op_sel_hi:[1,0,1] neg_lo:[0,1,0]
    v_cvt_pk_bf16_f32 v108, v86, v87
    v_pk_mul_f32 v[88:89], v[86:87], v[80:81] op_sel:[0,0] op_sel_hi:[0,1]
    v_pk_fma_f32 v[86:87], v[86:87], v[80:81], v[88:89] op_sel:[1,1,0] op_sel_hi:[1,0,1] neg_lo:[0,1,0]
    v_cvt_pk_bf16_f32 v109, v86, v87
    v_pk_mul_f32 v[88:89], v[86:87], v[80:81] op_sel:[0,0] op_sel_hi:[0,1]
    v_pk_fma_f32 v[86:87], v[86:87], v[80:81], v[88:89] op_sel:[1,1,0] op_sel_hi:[1,0,1] neg_lo:[0,1,0]
    v_cvt_pk_bf16_f32 v110, v86, v87
    ds_write_addtid_b32 v119 offset:8704
    ds_write_addtid_b32 v104 offset:8976
    ds_write_addtid_b32 v105 offset:9248
    ds_write_addtid_b32 v106 offset:9520
    ds_write_addtid_b32 v107 offset:9792
    ds_write_addtid_b32 v108 offset:10064
    ds_write_addtid_b32 v109 offset:10336
    ds_write_addtid_b32 v110 offset:10608
    v_pk_mul_f32 v[88:89], v[86:87], v[80:81] op_sel:[0,0] op_sel_hi:[0,1]
    v_pk_fma_f32 v[86:87], v[86:87], v[80:81], v[88:89] op_sel:[1,1,0] op_sel_hi:[1,0,1] neg_lo:[0,1,0]
    v_cvt_pk_bf16_f32 v111, v86, v87
    v_pk_mul_f32 v[88:89], v[86:87], v[80:81] op_sel:[0,0] op_sel_hi:[0,1]
    v_pk_fma_f32 v[86:87], v[86:87], v[80:81], v[88:89] op_sel:[1,1,0] op_sel_hi:[1,0,1] neg_lo:[0,1,0]
    v_cvt_pk_bf16_f32 v112, v86, v87
    v_pk_mul_f32 v[88:89], v[86:87], v[80:81] op_sel:[0,0] op_sel_hi:[0,1]
    v_pk_fma_f32 v[86:87], v[86:87], v[80:81], v[88:89] op_sel:[1,1,0] op_sel_hi:[1,0,1] neg_lo:[0,1,0]
    v_cvt_pk_bf16_f32 v113, v86, v87
    v_pk_mul_f32 v[88:89], v[86:87], v[80:81] op_sel:[0,0] op_sel_hi:[0,1]
    v_pk_fma_f32 v[86:87], v[86:87], v[80:81], v[88:89] op_sel:[1,1,0] op_sel_hi:[1,0,1] neg_lo:[0,1,0]
    v_cvt_pk_bf16_f32 v114, v86, v87
    v_pk_mul_f32 v[88:89], v[86:87], v[80:81] op_sel:[0,0] op_sel_hi:[0,1]
    v_pk_fma_f32 v[86:87], v[86:87], v[80:81], v[88:89] op_sel:[1,1,0] op_sel_hi:[1,0,1] neg_lo:[0,1,0]
    v_cvt_pk_bf16_f32 v115, v86, v87
    v_pk_mul_f32 v[88:89], v[86:87], v[80:81] op_sel:[0,0] op_sel_hi:[0,1]
    v_pk_fma_f32 v[86:87], v[86:87], v[80:81], v[88:89] op_sel:[1,1,0] op_sel_hi:[1,0,1] neg_lo:[0,1,0]
    v_cvt_pk_bf16_f32 v116, v86, v87
    v_pk_mul_f32 v[88:89], v[86:87], v[80:81] op_sel:[0,0] op_sel_hi:[0,1]
    v_pk_fma_f32 v[86:87], v[86:87], v[80:81], v[88:89] op_sel:[1,1,0] op_sel_hi:[1,0,1] neg_lo:[0,1,0]
    v_cvt_pk_bf16_f32 v117, v86, v87
    v_pk_mul_f32 v[88:89], v[86:87], v[80:81] op_sel:[0,0] op_sel_hi:[0,1]
    v_pk_fma_f32 v[86:87], v[86:87], v[80:81], v[88:89] op_sel:[1,1,0] op_sel_hi:[1,0,1] neg_lo:[0,1,0]
    v_cvt_pk_bf16_f32 v118, v86, v87
    ds_write_addtid_b32 v111 offset:10880
    ds_write_addtid_b32 v112 offset:11152
    ds_write_addtid_b32 v113 offset:11424
    ds_write_addtid_b32 v114 offset:11696
    ds_write_addtid_b32 v115 offset:11968
    ds_write_addtid_b32 v116 offset:12240
    ds_write_addtid_b32 v117 offset:12512
    ds_write_addtid_b32 v118 offset:12784
    s_cmp_eq_u32 s71, 2
    s_cselect_b32 s66, 81920, s66
    s_cselect_b32 s29, 0x7fff0000, s29
    s_mul_i32 s93, s67, 1280
    s_lshl_b32 s28, s67, 10
    s_add_u32 m0, s66, s28
    s_add_u32 s93, s93, s29
    s_add_u32 s67, s67, 1
    buffer_load_dwordx4 v250, s[32:35], s93 offen lds
    s_mov_b32 m0, s65
    s_and_b32 s67, s67, 7
    s_nop 0
    v_pk_mul_f32 v[88:89], v[86:87], v[80:81] op_sel:[0,0] op_sel_hi:[0,1]
    v_pk_fma_f32 v[86:87], v[86:87], v[80:81], v[88:89] op_sel:[1,1,0] op_sel_hi:[1,0,1] neg_lo:[0,1,0]
    v_cvt_pk_bf16_f32 v119, v86, v87
    v_pk_mul_f32 v[88:89], v[86:87], v[80:81] op_sel:[0,0] op_sel_hi:[0,1]
    v_pk_fma_f32 v[86:87], v[86:87], v[80:81], v[88:89] op_sel:[1,1,0] op_sel_hi:[1,0,1] neg_lo:[0,1,0]
    v_cvt_pk_bf16_f32 v104, v86, v87
    v_pk_mul_f32 v[88:89], v[86:87], v[80:81] op_sel:[0,0] op_sel_hi:[0,1]
    v_pk_fma_f32 v[86:87], v[86:87], v[80:81], v[88:89] op_sel:[1,1,0] op_sel_hi:[1,0,1] neg_lo:[0,1,0]
    v_cvt_pk_bf16_f32 v105, v86, v87
    v_pk_mul_f32 v[88:89], v[86:87], v[80:81] op_sel:[0,0] op_sel_hi:[0,1]
    v_pk_fma_f32 v[86:87], v[86:87], v[80:81], v[88:89] op_sel:[1,1,0] op_sel_hi:[1,0,1] neg_lo:[0,1,0]
    v_cvt_pk_bf16_f32 v106, v86, v87
    v_pk_mul_f32 v[88:89], v[86:87], v[80:81] op_sel:[0,0] op_sel_hi:[0,1]
    v_pk_fma_f32 v[86:87], v[86:87], v[80:81], v[88:89] op_sel:[1,1,0] op_sel_hi:[1,0,1] neg_lo:[0,1,0]
    v_cvt_pk_bf16_f32 v107, v86, v87
    ds_write_addtid_b32 v119 offset:13056
    ds_write_addtid_b32 v104 offset:13328
    ds_write_addtid_b32 v105 offset:13600
    ds_write_addtid_b32 v106 offset:13872
    ds_write_addtid_b32 v107 offset:14144
    ds_read_b128 a[4:7], v123 offset:5712
    ds_read_b128 a[12:15], v123 offset:5744
    ds_read_b128 a[20:23], v123 offset:5776
    ds_read_b128 a[28:31], v123 offset:5808
    ds_read_b128 a[36:39], v123 offset:5840
    ds_read_b128 a[44:47], v123 offset:5872
    ds_read_b128 a[52:55], v123 offset:5904
    ds_read_b128 a[60:63], v123 offset:5936
    v_mul_f32 v10, 1069066811, v16
    v_mul_f32 v11, v17, v120
    v_exp_f32 v10, v10
    v_mul_f32 v11, 1042479491, v11
    v_mul_f32 v92, v18, v121
    v_cvt_pk_bf16_f32 v10, v10, v10
    v_mul_f32 v93, v19, v121
    v_and_b32 v10, 0xffff0000, v10
    v_mul_f32 v10, v10, v120
    v_mul_f32 v10, 3216550459, v10
    v_fract_f32 v13, v11
    v_exp_f32 v12, v10
    s_waitcnt lgkmcnt(7)
    v_mfma_f32_32x32x16_bf16 v[142:157], a[0:3], a[4:7], v[142:157]
    v_cos_f32 v14, v13
    v_sin_f32 v15, v13
    v_mul_f32 v6, 0x41000000, v10
    v_mul_f32 v7, 0x41000000, v11
    s_waitcnt lgkmcnt(6)
    v_mfma_f32_32x32x16_bf16 v[142:157], a[8:11], a[12:15], v[142:157]
    v_mul_f32 v78, v12, v14
    v_mul_f32 v79, v12, v15
    v_exp_f32 v6, v6
    v_fract_f32 v7, v7
    s_waitcnt lgkmcnt(5)
    v_mfma_f32_32x32x16_bf16 v[142:157], a[16:19], a[20:23], v[142:157]
    v_mul_f32 v12, 0x43800000, v10
    v_cos_f32 v8, v7
    v_sin_f32 v9, v7
    v_mul_f32 v13, 0x43800000, v11
    s_waitcnt lgkmcnt(4)
    v_mfma_f32_32x32x16_bf16 v[142:157], a[24:27], a[28:31], v[142:157]
    v_exp_f32 v12, v12
    v_fract_f32 v13, v13
    v_mul_f32 v80, v6, v8
    v_mul_f32 v81, v6, v9
    s_waitcnt lgkmcnt(3)
    v_mfma_f32_32x32x16_bf16 v[142:157], a[32:35], a[36:39], v[142:157]
    v_cos_f32 v14, v13
    v_sin_f32 v15, v13
    v_mov_b32 v16, v20
    v_mul_f32 v82, v12, v14
    s_waitcnt lgkmcnt(2)
    v_mfma_f32_32x32x16_bf16 v[142:157], a[40:43], a[44:47], v[142:157]
    v_mul_f32 v83, v12, v15
    v_mov_b32 v17, v21
    v_mov_b32 v18, v22
    v_mov_b32 v19, v23
    s_waitcnt lgkmcnt(1)
    v_mfma_f32_32x32x16_bf16 v[142:157], a[48:51], a[52:55], v[142:157]
    v_mov_b32 v20, v24
    v_mov_b32 v21, v25
    v_mov_b32 v22, v26
    v_mov_b32 v23, v27
    s_waitcnt lgkmcnt(0)
    v_mfma_f32_32x32x16_bf16 v[142:157], a[56:59], a[60:63], v[142:157]
    s_add_u32 s71, s71, 1
    s_cmp_lt_u32 s71, 3
    s_cbranch_scc1 L_kgen
    s_waitcnt vmcnt(1)
    ds_read_b64 v[28:29], v252 offset:0
    ds_read_b64 v[30:31], v252 offset:1024
    ds_read_b64 v[32:33], v252 offset:2048
    ds_read_b64 v[34:35], v252 offset:3072
    ds_read_b64 v[36:37], v252 offset:4096
    ds_read_b64 v[38:39], v252 offset:5120
    ds_read_b64 v[40:41], v252 offset:6144
    ds_read_b64 v[42:43], v252 offset:7168
    buffer_load_dwordx4 v[110:113], v249, s[36:39], 0 offen offset:0 sc1
    buffer_load_dwordx4 v[114:117], v249, s[36:39], 0 offen offset:16 sc1
    buffer_load_dwordx4 v[118:121], v249, s[36:39], 0 offen offset:32 sc1
    buffer_load_dwordx4 v[122:125], v249, s[36:39], 0 offen offset:48 sc1
    buffer_load_dword v9, v253, s[36:39], 0 offen sc1
    s_mov_b32 s92, 0x01000100
    s_mov_b32 s93, 0x03020302
    v_mov_b32_e64 v5, 0
    v_cvt_pk_bf16_f32 v16, v142, v143
    v_cvt_pk_bf16_f32 v17, v144, v145
    v_cvt_pk_bf16_f32 v18, v146, v147
    v_cvt_pk_bf16_f32 v19, v148, v149
    v_cvt_pk_bf16_f32 v20, v150, v151
    v_cvt_pk_bf16_f32 v21, v152, v153
    v_cvt_pk_bf16_f32 v22, v146, v146
    v_cvt_pk_bf16_f32 v23, v147, v147
    ds_write_b32 v232, v5
    ds_write_b64 v233, v[16:17] offset:32
    ds_write_b32 v234, v18
    ds_write_b32 v235, v19
    ds_write_b16 v236, v20 offset:1792
    ds_write_b16_d16_hi v236, v20 offset:1856
    ds_write_b16 v236, v21 offset:1920
    ds_write_b16_d16_hi v236, v21 offset:1984
    s_mov_b32 exec_lo, 1
    s_mov_b32 exec_hi, 1
    ds_write_b32 v237, v22 offset:544
    s_mov_b32 exec_hi, 0
    ds_write_b32 v237, v23 offset:548
    s_mov_b64 exec, -1
    v_mov_b32_e64 v79, s65
    ds_read2_b32 v[186:187], v239 offset0:192 offset1:193
    ds_read2_b32 v[184:185], v239 offset0:128 offset1:129
    ds_read2_b32 v[182:183], v239 offset0:0 offset1:1
    ds_read_b64 v[174:175], v238 offset:32
    ds_read_b64 v[176:177], v238 offset:40
    ds_read_b64 v[178:179], v238 offset:0
    ds_read_b64 v[180:181], v238 offset:8
    s_mov_b32 s71, 0xffff0000
    s_waitcnt lgkmcnt(15)
    v_lshlrev_b32 v46, 16, v28
    v_and_b32 v47, s71, v28
    v_lshlrev_b32 v48, 16, v29
    v_and_b32 v49, s71, v29
    v_lshlrev_b32 v50, 16, v30
    v_and_b32 v51, s71, v30
    v_lshlrev_b32 v52, 16, v31
    v_and_b32 v53, s71, v31
    v_lshlrev_b32 v54, 16, v32
    v_and_b32 v55, s71, v32
    v_lshlrev_b32 v56, 16, v33
    v_and_b32 v57, s71, v33
    v_lshlrev_b32 v58, 16, v34
    v_and_b32 v59, s71, v34
    v_lshlrev_b32 v60, 16, v35
    v_and_b32 v61, s71, v35
    v_lshlrev_b32 v62, 16, v36
    v_and_b32 v63, s71, v36
    v_lshlrev_b32 v64, 16, v37
    v_and_b32 v65, s71, v37
    v_lshlrev_b32 v66, 16, v38
    v_and_b32 v67, s71, v38
    v_lshlrev_b32 v68, 16, v39
    v_and_b32 v69, s71, v39
    v_lshlrev_b32 v70, 16, v40
    v_and_b32 v71, s71, v40
    v_lshlrev_b32 v72, 16, v41
    v_and_b32 v73, s71, v41
    v_lshlrev_b32 v74, 16, v42
    v_and_b32 v75, s71, v42
    v_lshlrev_b32 v76, 16, v43
    v_and_b32 v77, s71, v43
    ds_read_u16 v78, v79 offset:1792
    v_mov_b32 v80, 0
    v_mov_b32 v81, 0
    ds_write_b64 v2, v[80:81] offset:2080
    s_waitcnt lgkmcnt(8)
    ds_write_b16 v242, v187 offset:9472
    ds_write_b16_d16_hi v242, v186 offset:10240
    ds_write_b16 v242, v187 offset:9662
    ds_write_b16_d16_hi v242, v186 offset:10430
    ds_write_b16 v242, v187 offset:9852
    ds_write_b16_d16_hi v242, v186 offset:10620
    ds_write_b16 v242, v187 offset:10042
    ds_write_b16_d16_hi v242, v186 offset:10810
    s_waitcnt lgkmcnt(15)
    s_nop 0
    v_perm_b32 v208, v184, v184, s92
    v_mov_b32_e64 v209, v184
    v_perm_b32 v210, v184, v184, s93
    v_perm_b32 v211, v185, v185, s92
    v_perm_b32 v212, v184, v184, s92
    v_perm_b32 v213, v184, v184, s93
    v_alignbit_b32 v214, v185, v184, 16
    v_perm_b32 v215, v185, v185, s92
    v_mov_b32_e64 v216, v184
    v_perm_b32 v217, v184, v184, s93
    v_perm_b32 v218, v185, v185, s92
    v_perm_b32 v219, v185, v185, s92
    v_perm_b32 v220, v184, v184, s93
    v_alignbit_b32 v221, v185, v184, 16
    v_perm_b32 v222, v185, v185, s92
    v_perm_b32 v223, v185, v185, s92
    s_waitcnt lgkmcnt(9)
    s_nop 0
    ds_write_b16 v3, v78 offset:2080
    ds_write_b128 v241, v[208:211] offset:1056
    ds_write_b128 v241, v[212:215] offset:3424
    ds_write_b128 v241, v[216:219] offset:5792
    ds_write_b128 v241, v[220:223] offset:8160
    v_perm_b32 v200, v182, v182, s92
    v_alignbit_b32 v201, v183, v182, 16
    v_mov_b32_e64 v202, v182
    v_perm_b32 v203, v183, v183, s92
    v_alignbit_b32 v204, v183, v182, 16
    v_perm_b32 v205, v183, v183, s92
    v_perm_b32 v206, v183, v183, s92
    v_mov_b32_e64 v207, v183
    v_alignbit_b32 v188, v175, v174, 16
    v_alignbit_b32 v189, v176, v175, 16
    v_mov_b32 v190, v175
    v_mov_b32 v191, v176
    v_alignbit_b32 v192, v176, v175, 16
    v_alignbit_b32 v193, v177, v176, 16
    v_alignbit_b32 v194, v179, v178, 16
    v_alignbit_b32 v195, v180, v179, 16
    v_mov_b32 v196, v179
    v_mov_b32 v197, v180
    v_alignbit_b32 v198, v180, v179, 16
    v_alignbit_b32 v199, v181, v180, 16
    ds_write_b64 v240, v[200:201] offset:544
    ds_write_b64 v240, v[202:203] offset:2912
    ds_write_b64 v240, v[204:205] offset:5280
    ds_write_b64 v240, v[206:207] offset:7648
    ds_write_b64 v240, v[174:175] offset:32
    ds_write_b64 v240, v[188:189] offset:2400
    ds_write_b64 v240, v[190:191] offset:4768
    ds_write_b64 v240, v[192:193] offset:7136
    ds_write_b64 v240, v[178:179] offset:0
    ds_write_b64 v240, v[194:195] offset:2368
    ds_write_b64 v240, v[196:197] offset:4736
    ds_write_b64 v240, v[198:199] offset:7104
    ds_read_b64 v[174:175], v244 offset:0
    ds_read_b64 v[176:177], v244 offset:8
    ds_read_b64 v[178:179], v244 offset:512
    ds_read_b64 v[180:181], v244 offset:520
    ds_read_b64 v[182:183], v244 offset:1024
    ds_read_b64 v[184:185], v244 offset:1032
    ds_read_b64 v[186:187], v244 offset:1536
    ds_read_b64 v[188:189], v244 offset:1544
    ds_read_b64 v[190:191], v244 offset:2048
    ds_read_b64 v[192:193], v244 offset:2056
    s_mov_b32 s93, 0xffff0000
    s_mov_b32 s65, 0
L_sweep:
    s_waitcnt vmcnt(0)
    v_xor_b32_e64 v10, s60, v111
    v_bitop3_b32 v10, v113, s60, v10 bitop3:0xbe
    v_bitop3_b32 v10, v115, s60, v10 bitop3:0xbe
    v_bitop3_b32 v10, v117, s60, v10 bitop3:0xbe
    v_bitop3_b32 v10, v119, s60, v10 bitop3:0xbe
    v_bitop3_b32 v10, v121, s60, v10 bitop3:0xbe
    v_bitop3_b32 v10, v123, s60, v10 bitop3:0xbe
    v_bitop3_b32 v10, v125, s60, v10 bitop3:0xbe
    v_bitop3_b32 v10, v9, s60, v10 bitop3:0xbe
    v_cmp_ne_u32 vcc, 0, v10
    v_lshlrev_b32 v126, 16, v110
    v_lshlrev_b32 v128, 16, v112
    v_lshlrev_b32 v130, 16, v114
    v_lshlrev_b32 v132, 16, v116
    v_lshlrev_b32 v134, 16, v118
    v_lshlrev_b32 v136, 16, v120
    v_lshlrev_b32 v138, 16, v122
    v_lshlrev_b32 v140, 16, v124
    s_cbranch_vccnz L_sweep_again
L_swept:
    v_rcp_f32 v126, v126
    v_and_b32 v127, s93, v110
    v_rcp_f32 v128, v128
    v_and_b32 v129, s93, v112
    v_rcp_f32 v130, v130
    v_and_b32 v131, s93, v114
    v_rcp_f32 v132, v132
    v_and_b32 v133, s93, v116
    v_rcp_f32 v134, v134
    v_and_b32 v135, s93, v118
    v_rcp_f32 v136, v136
    v_and_b32 v137, s93, v120
    v_rcp_f32 v138, v138
    v_and_b32 v139, s93, v122
    v_rcp_f32 v140, v140
    v_and_b32 v141, s93, v124
    v_mul_f32 v127, v127, v126
    v_mul_f32 v129, v129, v128
    v_mul_f32 v131, v131, v130
    v_mul_f32 v133, v133, v132
    v_mul_f32 v135, v135, v134
    v_mul_f32 v137, v137, v136
    v_mul_f32 v139, v139, v138
    v_mul_f32 v141, v141, v140
    v_pk_fma_f32 v[78:79], v[46:47], v[126:127], v[126:127] op_sel:[0,0,1] op_sel_hi:[1,0,1] neg_lo:[0,0,1] neg_hi:[0,0,1]
    v_pk_fma_f32 v[80:81], v[48:49], v[126:127], v[126:127] op_sel:[0,0,1] op_sel_hi:[1,0,1] neg_lo:[0,0,1] neg_hi:[0,0,1]
    v_pk_fma_f32 v[82:83], v[50:51], v[128:129], v[128:129] op_sel:[0,0,1] op_sel_hi:[1,0,1] neg_lo:[0,0,1] neg_hi:[0,0,1]
    v_pk_fma_f32 v[84:85], v[52:53], v[128:129], v[128:129] op_sel:[0,0,1] op_sel_hi:[1,0,1] neg_lo:[0,0,1] neg_hi:[0,0,1]
    v_pk_fma_f32 v[86:87], v[54:55], v[130:131], v[130:131] op_sel:[0,0,1] op_sel_hi:[1,0,1] neg_lo:[0,0,1] neg_hi:[0,0,1]
    v_pk_fma_f32 v[88:89], v[56:57], v[130:131], v[130:131] op_sel:[0,0,1] op_sel_hi:[1,0,1] neg_lo:[0,0,1] neg_hi:[0,0,1]
    v_pk_fma_f32 v[90:91], v[58:59], v[132:133], v[132:133] op_sel:[0,0,1] op_sel_hi:[1,0,1] neg_lo:[0,0,1] neg_hi:[0,0,1]
    v_pk_fma_f32 v[92:93], v[60:61], v[132:133], v[132:133] op_sel:[0,0,1] op_sel_hi:[1,0,1] neg_lo:[0,0,1] neg_hi:[0,0,1]
    v_pk_fma_f32 v[94:95], v[62:63], v[134:135], v[134:135] op_sel:[0,0,1] op_sel_hi:[1,0,1] neg_lo:[0,0,1] neg_hi:[0,0,1]
    v_pk_fma_f32 v[96:97], v[64:65], v[134:135], v[134:135] op_sel:[0,0,1] op_sel_hi:[1,0,1] neg_lo:[0,0,1] neg_hi:[0,0,1]
    v_pk_fma_f32 v[98:99], v[66:67], v[136:137], v[136:137] op_sel:[0,0,1] op_sel_hi:[1,0,1] neg_lo:[0,0,1] neg_hi:[0,0,1]
    v_pk_fma_f32 v[100:101], v[68:69], v[136:137], v[136:137] op_sel:[0,0,1] op_sel_hi:[1,0,1] neg_lo:[0,0,1] neg_hi:[0,0,1]
    v_pk_fma_f32 v[102:103], v[70:71], v[138:139], v[138:139] op_sel:[0,0,1] op_sel_hi:[1,0,1] neg_lo:[0,0,1] neg_hi:[0,0,1]
    v_pk_fma_f32 v[104:105], v[72:73], v[138:139], v[138:139] op_sel:[0,0,1] op_sel_hi:[1,0,1] neg_lo:[0,0,1] neg_hi:[0,0,1]
    v_pk_fma_f32 v[106:107], v[74:75], v[140:141], v[140:141] op_sel:[0,0,1] op_sel_hi:[1,0,1] neg_lo:[0,0,1] neg_hi:[0,0,1]
    v_pk_fma_f32 v[108:109], v[76:77], v[140:141], v[140:141] op_sel:[0,0,1] op_sel_hi:[1,0,1] neg_lo:[0,0,1] neg_hi:[0,0,1]
    v_cvt_pk_bf16_f32 v28, v106, v102
    v_cvt_pk_bf16_f32 v29, v98, v94
    v_cvt_pk_bf16_f32 v30, v90, v86
    v_cvt_pk_bf16_f32 v31, v82, v78
    v_cvt_pk_bf16_f32 v32, v107, v103
    v_cvt_pk_bf16_f32 v33, v99, v95
    v_cvt_pk_bf16_f32 v34, v91, v87
    v_cvt_pk_bf16_f32 v35, v83, v79
    v_cvt_pk_bf16_f32 v36, v108, v104
    v_cvt_pk_bf16_f32 v37, v100, v96
    v_cvt_pk_bf16_f32 v38, v92, v88
    v_cvt_pk_bf16_f32 v39, v84, v80
    v_cvt_pk_bf16_f32 v40, v109, v105
    v_cvt_pk_bf16_f32 v41, v101, v97
    v_cvt_pk_bf16_f32 v42, v93, v89
    v_cvt_pk_bf16_f32 v43, v85, v81
    ds_write_b128 v248, v[28:31] offset:0
    ds_write_b128 v248, v[32:35] offset:4608
    ds_write_b128 v248, v[36:39] offset:9216
    ds_write_b128 v248, v[40:43] offset:13824
    s_waitcnt lgkmcnt(0)
    s_barrier
    ds_read_b128 v[110:113], v245 offset:3584
    ds_read_b128 v[114:117], v245 offset:3072
    ds_read_b128 v[118:121], v245 offset:2560
    ds_read_b128 v[122:125], v245 offset:2048
    ds_read_b128 v[126:129], v245 offset:1536
    ds_read_b128 v[130:133], v245 offset:1024
    ds_read_b128 v[134:137], v245 offset:512
    ds_read_b128 v[138:141], v245 offset:0
    s_waitcnt lgkmcnt(0)
    v_mfma_f32_16x16x32_bf16 v[142:145], v[174:177], v[110:113], 0
    ds_read_b64 a[0:1], v244 offset:64
    buffer_store_dword v255, v44, s[36:39], 0 offen sc1
    v_mfma_f32_16x16x32_bf16 v[146:149], v[174:177], v[114:117], 0
    ds_read_b64 a[2:3], v244 offset:72
    v_mov_b32 v40, -1
    v_mfma_f32_16x16x32_bf16 v[150:153], v[174:177], v[118:121], 0
    ds_read_b128 v[206:209], v245 offset:3648
    v_mov_b32 v41, -1
    v_mfma_f32_16x16x32_bf16 v[154:157], v[174:177], v[122:125], 0
    ds_read_b128 v[210:213], v245 offset:3136
    v_mov_b32 v42, -1
    v_mfma_f32_16x16x32_bf16 v[158:161], v[174:177], v[126:129], 0
    ds_read_b64 a[4:5], v244 offset:576
    v_mov_b32 v43, -1
    v_mfma_f32_16x16x32_bf16 v[162:165], v[174:177], v[130:133], 0
    ds_read_b64 a[6:7], v244 offset:584
    v_fmac_f32 v46, s94, v78
    v_mfma_f32_16x16x32_bf16 v[166:169], v[174:177], v[134:137], 0
    ds_read_b128 v[214:217], v245 offset:2624
    v_fmac_f32 v47, s95, v79
    v_mfma_f32_16x16x32_bf16 v[170:173], v[174:177], v[138:141], 0
    ds_read_b128 v[218:221], v245 offset:2112
    s_add_u32 s28, s3, 0
    buffer_store_dwordx4 v[40:43], v225, s[36:39], s28 offen sc1
    v_mfma_f32_16x16x32_bf16 v[146:149], v[178:181], v[110:113], v[146:149]
    ds_read_b64 a[8:9], v244 offset:1088
    v_fmac_f32 v48, s96, v80
    v_mfma_f32_16x16x32_bf16 v[150:153], v[178:181], v[114:117], v[150:153]
    ds_read_b64 a[10:11], v244 offset:1096
    v_fmac_f32 v49, s97, v81
    v_mfma_f32_16x16x32_bf16 v[154:157], v[178:181], v[118:121], v[154:157]
    ds_read_b128 a[32:35], v245 offset:1600
    v_fmac_f32 v50, s94, v82
    v_mfma_f32_16x16x32_bf16 v[158:161], v[178:181], v[122:125], v[158:161]
    ds_read_b128 a[36:39], v245 offset:1088
    v_fmac_f32 v51, s95, v83
    v_mfma_f32_16x16x32_bf16 v[162:165], v[178:181], v[126:129], v[162:165]
    ds_read_b64 a[12:13], v244 offset:1600
    v_fmac_f32 v52, s96, v84
    v_mfma_f32_16x16x32_bf16 v[166:169], v[178:181], v[130:133], v[166:169]
    ds_read_b64 a[14:15], v244 offset:1608
    v_fmac_f32 v53, s97, v85
    v_mfma_f32_16x16x32_bf16 v[170:173], v[178:181], v[134:137], v[170:173]
    ds_read_b128 a[40:43], v245 offset:576
    v_fmac_f32 v54, s94, v86
    v_mfma_f32_16x16x32_bf16 v[150:153], v[182:185], v[110:113], v[150:153]
    ds_read_b128 a[44:47], v245 offset:64
    s_add_u32 s28, s3, 49152
    buffer_store_dwordx4 v[40:43], v225, s[36:39], s28 offen sc1
    v_mfma_f32_16x16x32_bf16 v[154:157], v[182:185], v[114:117], v[154:157]
    ds_read_b128 a[16:19], v245 offset:3600
    v_fmac_f32 v55, s95, v87
    v_mfma_f32_16x16x32_bf16 v[158:161], v[182:185], v[118:121], v[158:161]
    ds_read_b128 a[20:23], v245 offset:3088
    v_fmac_f32 v56, s96, v88
    v_mfma_f32_16x16x32_bf16 v[162:165], v[182:185], v[122:125], v[162:165]
    ds_read_b128 a[24:27], v245 offset:2576
    v_fmac_f32 v57, s97, v89
    v_mfma_f32_16x16x32_bf16 v[166:169], v[182:185], v[126:129], v[166:169]
    ds_read_b128 a[28:31], v245 offset:2064
    v_fmac_f32 v58, s94, v90
    v_mfma_f32_16x16x32_bf16 v[170:173], v[182:185], v[130:133], v[170:173]
    v_fmac_f32 v59, s95, v91
    v_fmac_f32 v60, s96, v92
    v_mfma_f32_16x16x32_bf16 v[154:157], v[186:189], v[110:113], v[154:157]
    v_fmac_f32 v61, s97, v93
    v_fmac_f32 v62, s94, v94
    v_mfma_f32_16x16x32_bf16 v[158:161], v[186:189], v[114:117], v[158:161]
    v_fmac_f32 v63, s95, v95
    v_fmac_f32 v64, s96, v96
    v_mfma_f32_16x16x32_bf16 v[162:165], v[186:189], v[118:121], v[162:165]
    s_add_u32 s28, s3, 16384
    buffer_store_dwordx4 v[40:43], v225, s[36:39], s28 offen sc1
    v_mfma_f32_16x16x32_bf16 v[166:169], v[186:189], v[122:125], v[166:169]
    v_fmac_f32 v65, s97, v97
    v_fmac_f32 v66, s94, v98
    v_mfma_f32_16x16x32_bf16 v[170:173], v[186:189], v[126:129], v[170:173]
    v_fmac_f32 v67, s95, v99
    v_fmac_f32 v68, s96, v100
    v_mfma_f32_16x16x32_bf16 v[16:19], v[110:113], a[252:255], 0
    v_fmac_f32 v69, s97, v101
    v_fmac_f32 v70, s94, v102
    v_mfma_f32_16x16x32_bf16 v[20:23], v[114:117], a[252:255], 0
    v_fmac_f32 v71, s95, v103
    v_fmac_f32 v72, s96, v104
    v_mfma_f32_16x16x32_bf16 v[24:27], v[118:121], a[252:255], 0
    v_fmac_f32 v73, s97, v105
    v_fmac_f32 v74, s94, v106
    v_mfma_f32_16x16x32_bf16 v[28:31], v[122:125], a[252:255], 0
    v_fmac_f32 v75, s95, v107
    v_fmac_f32 v76, s96, v108
    v_mfma_f32_16x16x32_bf16 v[158:161], v[190:193], v[110:113], v[158:161]
    v_fmac_f32 v77, s97, v109
    v_mfma_f32_16x16x32_bf16 v[162:165], v[190:193], v[114:117], v[162:165]
    s_add_u32 s28, s3, 65536
    buffer_store_dwordx4 v[40:43], v225, s[36:39], s28 offen sc1
    v_mfma_f32_16x16x32_bf16 v[166:169], v[190:193], v[118:121], v[166:169]
    v_mfma_f32_16x16x32_bf16 v[170:173], v[190:193], v[122:125], v[170:173]
    s_waitcnt lgkmcnt(0)
    v_mfma_f32_16x16x32_bf16 v[142:145], a[0:3], v[206:209], v[142:145]
    ds_read_b64 v[174:175], v244 offset:128
    v_cvt_pk_bf16_f32 v194, v16, v17
    v_mfma_f32_16x16x32_bf16 v[146:149], a[0:3], v[210:213], v[146:149]
    ds_read_b64 v[176:177], v244 offset:136
    v_cvt_pk_bf16_f32 v195, v18, v19
    v_mfma_f32_16x16x32_bf16 v[150:153], a[0:3], v[214:217], v[150:153]
    ds_read_b128 v[110:113], v245 offset:3712
    v_cvt_pk_bf16_f32 v196, v20, v21
    v_mfma_f32_16x16x32_bf16 v[154:157], a[0:3], v[218:221], v[154:157]
    ds_read_b128 v[114:117], v245 offset:3200
    v_cvt_pk_bf16_f32 v197, v22, v23
    v_mfma_f32_16x16x32_bf16 v[158:161], a[0:3], a[32:35], v[158:161]
    ds_read_b64 v[178:179], v244 offset:640
    v_cvt_pk_bf16_f32 v198, v24, v25
    v_mfma_f32_16x16x32_bf16 v[162:165], a[0:3], a[36:39], v[162:165]
    ds_read_b64 v[180:181], v244 offset:648
    s_add_u32 s28, s3, 32768
    buffer_store_dwordx4 v[40:43], v225, s[36:39], s28 offen sc1
    v_mfma_f32_16x16x32_bf16 v[166:169], a[0:3], a[40:43], v[166:169]
    ds_read_b128 v[118:121], v245 offset:2688
    v_cvt_pk_bf16_f32 v199, v26, v27
    v_mfma_f32_16x16x32_bf16 v[170:173], a[0:3], a[44:47], v[170:173]
    ds_read_b128 v[122:125], v245 offset:2176
    v_cvt_pk_bf16_f32 v200, v28, v29
    v_mfma_f32_16x16x32_bf16 v[146:149], a[4:7], v[206:209], v[146:149]
    ds_read_b64 v[182:183], v244 offset:1152
    v_cvt_pk_bf16_f32 v201, v30, v31
    v_mfma_f32_16x16x32_bf16 v[150:153], a[4:7], v[210:213], v[150:153]
    ds_read_b64 v[184:185], v244 offset:1160
    v_mfma_f32_16x16x32_bf16 v[154:157], a[4:7], v[214:217], v[154:157]
    ds_read_b128 v[126:129], v245 offset:1664
    v_mfma_f32_16x16x32_bf16 v[158:161], a[4:7], v[218:221], v[158:161]
    ds_read_b128 v[130:133], v245 offset:1152
    v_mfma_f32_16x16x32_bf16 v[162:165], a[4:7], a[32:35], v[162:165]
    ds_read_b64 v[186:187], v244 offset:1664
    v_mfma_f32_16x16x32_bf16 v[166:169], a[4:7], a[36:39], v[166:169]
    ds_read_b64 v[188:189], v244 offset:1672
    s_add_u32 s28, s3, 81920
    buffer_store_dwordx4 v[40:43], v225, s[36:39], s28 offen sc1
    v_mfma_f32_16x16x32_bf16 v[170:173], a[4:7], a[40:43], v[170:173]
    ds_read_b128 v[134:137], v245 offset:640
    v_mfma_f32_16x16x32_bf16 v[150:153], a[8:11], v[206:209], v[150:153]
    ds_read_b128 v[138:141], v245 offset:128
    v_mfma_f32_16x16x32_bf16 v[154:157], a[8:11], v[210:213], v[154:157]
    v_mfma_f32_16x16x32_bf16 v[158:161], a[8:11], v[214:217], v[158:161]
    v_mfma_f32_16x16x32_bf16 v[162:165], a[8:11], v[218:221], v[162:165]
    v_mfma_f32_16x16x32_bf16 v[166:169], a[8:11], a[32:35], v[166:169]
    v_mfma_f32_16x16x32_bf16 v[170:173], a[8:11], a[36:39], v[170:173]
    v_mfma_f32_16x16x32_bf16 v[154:157], a[12:15], v[206:209], v[154:157]
    s_add_u32 s30, s48, 0
    buffer_load_dwordx4 a[48:51], v225, s[36:39], s30 offen offset:0 sc1
    v_mfma_f32_16x16x32_bf16 v[158:161], a[12:15], v[210:213], v[158:161]
    v_mfma_f32_16x16x32_bf16 v[162:165], a[12:15], v[214:217], v[162:165]
    v_mfma_f32_16x16x32_bf16 v[166:169], a[12:15], v[218:221], v[166:169]
    v_mfma_f32_16x16x32_bf16 v[170:173], a[12:15], a[32:35], v[170:173]
    v_mfma_f32_16x16x32_bf16 v[16:19], a[16:19], a[248:251], 0
    v_mfma_f32_16x16x32_bf16 v[20:23], a[20:23], a[248:251], 0
    v_mfma_f32_16x16x32_bf16 v[24:27], a[24:27], a[248:251], 0
    v_mfma_f32_16x16x32_bf16 v[28:31], a[28:31], a[248:251], 0
    buffer_load_dwordx4 a[52:55], v225, s[36:39], s30 offen offset:1024 sc1
    s_waitcnt lgkmcnt(0)
    v_mfma_f32_16x16x32_bf16 v[142:145], v[174:177], v[110:113], v[142:145]
    ds_read_b64 a[0:1], v244 offset:192
    s_nop 0
    v_cvt_pk_bf16_f32 v32, v16, v17
    v_mfma_f32_16x16x32_bf16 v[146:149], v[174:177], v[114:117], v[146:149]
    ds_read_b64 a[2:3], v244 offset:200
    v_cvt_pk_bf16_f32 v33, v18, v19
    v_mfma_f32_16x16x32_bf16 v[150:153], v[174:177], v[118:121], v[150:153]
    ds_read_b128 v[206:209], v245 offset:3776
    v_cvt_pk_bf16_f32 v34, v20, v21
    v_mfma_f32_16x16x32_bf16 v[154:157], v[174:177], v[122:125], v[154:157]
    ds_read_b128 v[210:213], v245 offset:3264
    v_cvt_pk_bf16_f32 v35, v22, v23
    v_mfma_f32_16x16x32_bf16 v[158:161], v[174:177], v[126:129], v[158:161]
    ds_read_b64 a[4:5], v244 offset:704
    v_cvt_pk_bf16_f32 v36, v24, v25
    v_mfma_f32_16x16x32_bf16 v[162:165], v[174:177], v[130:133], v[162:165]
    ds_read_b64 a[6:7], v244 offset:712
    v_cvt_pk_bf16_f32 v37, v26, v27
    v_mfma_f32_16x16x32_bf16 v[166:169], v[174:177], v[134:137], v[166:169]
    ds_read_b128 v[214:217], v245 offset:2752
    v_cvt_pk_bf16_f32 v38, v28, v29
    v_mfma_f32_16x16x32_bf16 v[170:173], v[174:177], v[138:141], v[170:173]
    ds_read_b128 v[218:221], v245 offset:2240
    buffer_load_dwordx4 a[56:59], v225, s[36:39], s30 offen offset:2048 sc1
    v_mfma_f32_16x16x32_bf16 v[146:149], v[178:181], v[110:113], v[146:149]
    ds_read_b64 a[8:9], v244 offset:1216
    v_cvt_pk_bf16_f32 v39, v30, v31
    v_mfma_f32_16x16x32_bf16 v[150:153], v[178:181], v[114:117], v[150:153]
    ds_read_b64 a[10:11], v244 offset:1224
    v_mov_b32 v86, 0
    v_mfma_f32_16x16x32_bf16 v[154:157], v[178:181], v[118:121], v[154:157]
    ds_read_b128 a[32:35], v245 offset:1728
    v_mov_b32 v87, 0
    v_mfma_f32_16x16x32_bf16 v[158:161], v[178:181], v[122:125], v[158:161]
    ds_read_b128 a[36:39], v245 offset:1216
    v_mov_b32 v96, 0
    v_mfma_f32_16x16x32_bf16 v[162:165], v[178:181], v[126:129], v[162:165]
    ds_read_b64 a[12:13], v244 offset:1728
    v_mov_b32 v97, 0
    v_mfma_f32_16x16x32_bf16 v[166:169], v[178:181], v[130:133], v[166:169]
    ds_read_b64 a[14:15], v244 offset:1736
    v_mfma_f32_16x16x32_bf16 v[170:173], v[178:181], v[134:137], v[170:173]
    ds_read_b128 a[40:43], v245 offset:704
    v_mfma_f32_16x16x32_bf16 v[150:153], v[182:185], v[110:113], v[150:153]
    ds_read_b128 a[44:47], v245 offset:192
    buffer_load_dwordx4 a[60:63], v225, s[36:39], s30 offen offset:3072 sc1
    v_mfma_f32_16x16x32_bf16 v[154:157], v[182:185], v[114:117], v[154:157]
    ds_read_b64 v[94:95], v243 offset:96
    v_mfma_f32_16x16x32_bf16 v[158:161], v[182:185], v[118:121], v[158:161]
    ds_read_b64 v[92:93], v243 offset:64
    v_mfma_f32_16x16x32_bf16 v[162:165], v[182:185], v[122:125], v[162:165]
    ds_read_b64 v[90:91], v243 offset:32
    v_mfma_f32_16x16x32_bf16 v[166:169], v[182:185], v[126:129], v[166:169]
    ds_read_b64 v[88:89], v243 offset:0
    v_mfma_f32_16x16x32_bf16 v[170:173], v[182:185], v[130:133], v[170:173]
    ds_read_b64 v[84:85], v243 offset:864
    v_mfma_f32_16x16x32_bf16 v[154:157], v[186:189], v[110:113], v[154:157]
    ds_read_b64 v[82:83], v243 offset:832
    v_mfma_f32_16x16x32_bf16 v[158:161], v[186:189], v[114:117], v[158:161]
    ds_read_b64 v[80:81], v243 offset:800
    v_mfma_f32_16x16x32_bf16 v[162:165], v[186:189], v[118:121], v[162:165]
    ds_read_b64 v[78:79], v243 offset:768
    buffer_load_dwordx4 a[64:67], v227, s[36:39], s30 offen sc1
    v_mfma_f32_16x16x32_bf16 v[166:169], v[186:189], v[122:125], v[166:169]
    v_mfma_f32_16x16x32_bf16 v[170:173], v[186:189], v[126:129], v[170:173]
    s_waitcnt lgkmcnt(0)
    v_mfma_f32_16x16x32_bf16 v[142:145], a[0:3], v[206:209], v[142:145]
    ds_read_b64 v[174:175], v244 offset:256
    v_mfma_f32_16x16x32_bf16 v[146:149], a[0:3], v[210:213], v[146:149]
    ds_read_b64 v[176:177], v244 offset:264
    v_mfma_f32_16x16x32_bf16 v[150:153], a[0:3], v[214:217], v[150:153]
    ds_read_b128 v[110:113], v245 offset:3840
    v_mfma_f32_16x16x32_bf16 v[154:157], a[0:3], v[218:221], v[154:157]
    ds_read_b128 v[114:117], v245 offset:3328
    v_mfma_f32_16x16x32_bf16 v[158:161], a[0:3], a[32:35], v[158:161]
    ds_read_b64 v[178:179], v244 offset:768
    v_mfma_f32_16x16x32_bf16 v[162:165], a[0:3], a[36:39], v[162:165]
    ds_read_b64 v[180:181], v244 offset:776
    s_add_u32 s30, s49, 0
    buffer_load_dwordx4 a[68:71], v225, s[36:39], s30 offen offset:0 sc1
    v_mfma_f32_16x16x32_bf16 v[166:169], a[0:3], a[40:43], v[166:169]
    ds_read_b128 v[118:121], v245 offset:2816
    v_mfma_f32_16x16x32_bf16 v[170:173], a[0:3], a[44:47], v[170:173]
    ds_read_b128 v[122:125], v245 offset:2304
    v_mfma_f32_16x16x32_bf16 v[146:149], a[4:7], v[206:209], v[146:149]
    ds_read_b64 v[182:183], v244 offset:1280
    v_mfma_f32_16x16x32_bf16 v[150:153], a[4:7], v[210:213], v[150:153]
    ds_read_b64 v[184:185], v244 offset:1288
    v_mfma_f32_16x16x32_bf16 v[154:157], a[4:7], v[214:217], v[154:157]
    ds_read_b128 v[126:129], v245 offset:1792
    v_mfma_f32_16x16x32_bf16 v[158:161], a[4:7], v[218:221], v[158:161]
    ds_read_b128 v[130:133], v245 offset:1280
    v_mfma_f32_16x16x32_bf16 v[162:165], a[4:7], a[32:35], v[162:165]
    ds_read_b64 v[186:187], v244 offset:1792
    v_mfma_f32_16x16x32_bf16 v[166:169], a[4:7], a[36:39], v[166:169]
    ds_read_b64 v[188:189], v244 offset:1800
    buffer_load_dwordx4 a[72:75], v225, s[36:39], s30 offen offset:1024 sc1
    v_mfma_f32_16x16x32_bf16 v[170:173], a[4:7], a[40:43], v[170:173]
    ds_read_b128 v[134:137], v245 offset:768
    v_mfma_f32_16x16x32_bf16 v[150:153], a[8:11], v[206:209], v[150:153]
    ds_read_b128 v[138:141], v245 offset:256
    v_mfma_f32_16x16x32_bf16 v[154:157], a[8:11], v[210:213], v[154:157]
    v_mfma_f32_16x16x32_bf16 v[158:161], a[8:11], v[214:217], v[158:161]
    v_mfma_f32_16x16x32_bf16 v[162:165], a[8:11], v[218:221], v[162:165]
    v_mfma_f32_16x16x32_bf16 v[166:169], a[8:11], a[32:35], v[166:169]
    v_mfma_f32_16x16x32_bf16 v[170:173], a[8:11], a[36:39], v[170:173]
    v_mfma_f32_16x16x32_bf16 v[154:157], a[12:15], v[206:209], v[154:157]
    buffer_load_dwordx4 a[76:79], v225, s[36:39], s30 offen offset:2048 sc1
    v_mfma_f32_16x16x32_bf16 v[158:161], a[12:15], v[210:213], v[158:161]
    v_mfma_f32_16x16x32_bf16 v[162:165], a[12:15], v[214:217], v[162:165]
    v_mfma_f32_16x16x32_bf16 v[166:169], a[12:15], v[218:221], v[166:169]
    v_mfma_f32_16x16x32_bf16 v[170:173], a[12:15], a[32:35], v[170:173]
    v_mfma_f32_16x16x32_bf16 v[158:161], v[32:35], v[94:97], v[158:161]
    v_mfma_f32_16x16x32_bf16 v[158:161], v[194:197], v[84:87], v[158:161]
    v_mfma_f32_16x16x32_bf16 v[162:165], v[32:35], v[92:95], v[162:165]
    v_mfma_f32_16x16x32_bf16 v[162:165], v[194:197], v[82:85], v[162:165]
    buffer_load_dwordx4 a[80:83], v225, s[36:39], s30 offen offset:3072 sc1
    v_mfma_f32_16x16x32_bf16 v[166:169], v[32:35], v[90:93], v[166:169]
    v_mfma_f32_16x16x32_bf16 v[166:169], v[194:197], v[80:83], v[166:169]
    v_mfma_f32_16x16x32_bf16 v[166:169], v[36:39], v[94:97], v[166:169]
    v_mfma_f32_16x16x32_bf16 v[166:169], v[198:201], v[84:87], v[166:169]
    v_mfma_f32_16x16x32_bf16 v[170:173], v[32:35], v[88:91], v[170:173]
    v_mfma_f32_16x16x32_bf16 v[170:173], v[194:197], v[78:81], v[170:173]
    v_mfma_f32_16x16x32_bf16 v[170:173], v[36:39], v[92:95], v[170:173]
    v_mfma_f32_16x16x32_bf16 v[170:173], v[198:201], v[82:85], v[170:173]
    buffer_load_dwordx4 a[84:87], v227, s[36:39], s30 offen sc1
    s_waitcnt lgkmcnt(0)
    v_mfma_f32_16x16x32_bf16 v[142:145], v[174:177], v[110:113], v[142:145]
    ds_read_b64 a[0:1], v244 offset:320
    v_mfma_f32_16x16x32_bf16 v[146:149], v[174:177], v[114:117], v[146:149]
    ds_read_b64 a[2:3], v244 offset:328
    v_mfma_f32_16x16x32_bf16 v[150:153], v[174:177], v[118:121], v[150:153]
    ds_read_b128 v[206:209], v245 offset:3904
    v_mfma_f32_16x16x32_bf16 v[154:157], v[174:177], v[122:125], v[154:157]
    ds_read_b128 v[210:213], v245 offset:3392
    v_mfma_f32_16x16x32_bf16 v[158:161], v[174:177], v[126:129], v[158:161]
    ds_read_b64 a[4:5], v244 offset:832
    v_mfma_f32_16x16x32_bf16 v[162:165], v[174:177], v[130:133], v[162:165]
    ds_read_b64 a[6:7], v244 offset:840
    v_mfma_f32_16x16x32_bf16 v[166:169], v[174:177], v[134:137], v[166:169]
    ds_read_b128 v[214:217], v245 offset:2880
    v_mfma_f32_16x16x32_bf16 v[170:173], v[174:177], v[138:141], v[170:173]
    ds_read_b128 v[218:221], v245 offset:2368
    s_add_u32 s30, s50, 0
    buffer_load_dwordx4 a[88:91], v225, s[36:39], s30 offen offset:0 sc1
    v_mfma_f32_16x16x32_bf16 v[146:149], v[178:181], v[110:113], v[146:149]
    ds_read_b64 a[8:9], v244 offset:1344
    v_mfma_f32_16x16x32_bf16 v[150:153], v[178:181], v[114:117], v[150:153]
    ds_read_b64 a[10:11], v244 offset:1352
    v_mfma_f32_16x16x32_bf16 v[154:157], v[178:181], v[118:121], v[154:157]
    ds_read_b128 a[32:35], v245 offset:1856
    v_mfma_f32_16x16x32_bf16 v[158:161], v[178:181], v[122:125], v[158:161]
    ds_read_b128 a[36:39], v245 offset:1344
    v_mfma_f32_16x16x32_bf16 v[162:165], v[178:181], v[126:129], v[162:165]
    ds_read_b64 a[12:13], v244 offset:1856
    v_mfma_f32_16x16x32_bf16 v[166:169], v[178:181], v[130:133], v[166:169]
    ds_read_b64 a[14:15], v244 offset:1864
    v_mfma_f32_16x16x32_bf16 v[170:173], v[178:181], v[134:137], v[170:173]
    ds_read_b128 a[40:43], v245 offset:832
    v_mfma_f32_16x16x32_bf16 v[150:153], v[182:185], v[110:113], v[150:153]
    ds_read_b128 a[44:47], v245 offset:320
    buffer_load_dwordx4 a[92:95], v225, s[36:39], s30 offen offset:1024 sc1
    v_mfma_f32_16x16x32_bf16 v[154:157], v[182:185], v[114:117], v[154:157]
    v_mfma_f32_16x16x32_bf16 v[158:161], v[182:185], v[118:121], v[158:161]
    v_mfma_f32_16x16x32_bf16 v[162:165], v[182:185], v[122:125], v[162:165]
    v_mfma_f32_16x16x32_bf16 v[166:169], v[182:185], v[126:129], v[166:169]
    v_mfma_f32_16x16x32_bf16 v[170:173], v[182:185], v[130:133], v[170:173]
    v_mfma_f32_16x16x32_bf16 v[154:157], v[186:189], v[110:113], v[154:157]
    v_mfma_f32_16x16x32_bf16 v[158:161], v[186:189], v[114:117], v[158:161]
    v_mfma_f32_16x16x32_bf16 v[162:165], v[186:189], v[118:121], v[162:165]
    buffer_load_dwordx4 a[96:99], v225, s[36:39], s30 offen offset:2048 sc1
    v_mfma_f32_16x16x32_bf16 v[166:169], v[186:189], v[122:125], v[166:169]
    v_mfma_f32_16x16x32_bf16 v[170:173], v[186:189], v[126:129], v[170:173]
    s_waitcnt lgkmcnt(0)
    v_mfma_f32_16x16x32_bf16 v[142:145], a[0:3], v[206:209], v[142:145]
    ds_read_b64 v[174:175], v244 offset:384
    v_mfma_f32_16x16x32_bf16 v[146:149], a[0:3], v[210:213], v[146:149]
    ds_read_b64 v[176:177], v244 offset:392
    v_mfma_f32_16x16x32_bf16 v[150:153], a[0:3], v[214:217], v[150:153]
    ds_read_b128 v[110:113], v245 offset:3968
    v_mfma_f32_16x16x32_bf16 v[154:157], a[0:3], v[218:221], v[154:157]
    ds_read_b128 v[114:117], v245 offset:3456
    v_mfma_f32_16x16x32_bf16 v[158:161], a[0:3], a[32:35], v[158:161]
    ds_read_b64 v[178:179], v244 offset:896
    v_mfma_f32_16x16x32_bf16 v[162:165], a[0:3], a[36:39], v[162:165]
    ds_read_b64 v[180:181], v244 offset:904
    buffer_load_dwordx4 a[100:103], v225, s[36:39], s30 offen offset:3072 sc1
    v_mfma_f32_16x16x32_bf16 v[166:169], a[0:3], a[40:43], v[166:169]
    ds_read_b128 v[118:121], v245 offset:2944
    v_mfma_f32_16x16x32_bf16 v[170:173], a[0:3], a[44:47], v[170:173]
    ds_read_b128 v[122:125], v245 offset:2432
    v_mfma_f32_16x16x32_bf16 v[146:149], a[4:7], v[206:209], v[146:149]
    ds_read_b64 v[182:183], v244 offset:1408
    v_mfma_f32_16x16x32_bf16 v[150:153], a[4:7], v[210:213], v[150:153]
    ds_read_b64 v[184:185], v244 offset:1416
    v_mfma_f32_16x16x32_bf16 v[154:157], a[4:7], v[214:217], v[154:157]
    ds_read_b128 v[126:129], v245 offset:1920
    v_mfma_f32_16x16x32_bf16 v[158:161], a[4:7], v[218:221], v[158:161]
    ds_read_b128 v[130:133], v245 offset:1408
    v_mfma_f32_16x16x32_bf16 v[162:165], a[4:7], a[32:35], v[162:165]
    ds_read_b64 v[186:187], v244 offset:1920
    v_mfma_f32_16x16x32_bf16 v[166:169], a[4:7], a[36:39], v[166:169]
    ds_read_b64 v[188:189], v244 offset:1928
    buffer_load_dwordx4 a[104:107], v227, s[36:39], s30 offen sc1
    v_mfma_f32_16x16x32_bf16 v[170:173], a[4:7], a[40:43], v[170:173]
    ds_read_b128 v[134:137], v245 offset:896
    v_mfma_f32_16x16x32_bf16 v[150:153], a[8:11], v[206:209], v[150:153]
    ds_read_b128 v[138:141], v245 offset:384
    v_mfma_f32_16x16x32_bf16 v[154:157], a[8:11], v[210:213], v[154:157]
    v_mfma_f32_16x16x32_bf16 v[158:161], a[8:11], v[214:217], v[158:161]
    v_mfma_f32_16x16x32_bf16 v[162:165], a[8:11], v[218:221], v[162:165]
    v_mfma_f32_16x16x32_bf16 v[166:169], a[8:11], a[32:35], v[166:169]
    v_mfma_f32_16x16x32_bf16 v[170:173], a[8:11], a[36:39], v[170:173]
    v_mfma_f32_16x16x32_bf16 v[154:157], a[12:15], v[206:209], v[154:157]
    s_add_u32 s30, s51, 0
    buffer_load_dwordx4 a[108:111], v225, s[36:39], s30 offen offset:0 sc1
    v_mfma_f32_16x16x32_bf16 v[158:161], a[12:15], v[210:213], v[158:161]
    v_mfma_f32_16x16x32_bf16 v[162:165], a[12:15], v[214:217], v[162:165]
    v_mfma_f32_16x16x32_bf16 v[166:169], a[12:15], v[218:221], v[166:169]
    v_mfma_f32_16x16x32_bf16 v[170:173], a[12:15], a[32:35], v[170:173]
    s_waitcnt lgkmcnt(0)
    v_mfma_f32_16x16x32_bf16 v[142:145], v[174:177], v[110:113], v[142:145]
    ds_read_b64 a[0:1], v244 offset:448
    buffer_load_dword v10, v226, s[36:39], 0 offen sc1
    v_mfma_f32_16x16x32_bf16 v[146:149], v[174:177], v[114:117], v[146:149]
    ds_read_b64 a[2:3], v244 offset:456
    buffer_load_dword v9, v254, s[36:39], 0 offen sc1
    v_mfma_f32_16x16x32_bf16 v[150:153], v[174:177], v[118:121], v[150:153]
    ds_read_b128 v[206:209], v245 offset:4032
    v_mfma_f32_16x16x32_bf16 v[154:157], v[174:177], v[122:125], v[154:157]
    ds_read_b128 v[210:213], v245 offset:3520
    buffer_load_dwordx4 a[112:115], v225, s[36:39], s30 offen offset:1024 sc1
    v_mfma_f32_16x16x32_bf16 v[158:161], v[174:177], v[126:129], v[158:161]
    ds_read_b64 a[4:5], v244 offset:960
    v_mfma_f32_16x16x32_bf16 v[162:165], v[174:177], v[130:133], v[162:165]
    ds_read_b64 a[6:7], v244 offset:968
    v_mfma_f32_16x16x32_bf16 v[166:169], v[174:177], v[134:137], v[166:169]
    ds_read_b128 v[214:217], v245 offset:3008
    v_mfma_f32_16x16x32_bf16 v[170:173], v[174:177], v[138:141], v[170:173]
    ds_read_b128 v[218:221], v245 offset:2496
    v_mfma_f32_16x16x32_bf16 v[146:149], v[178:181], v[110:113], v[146:149]
    ds_read_b64 a[8:9], v244 offset:1472
    v_mfma_f32_16x16x32_bf16 v[150:153], v[178:181], v[114:117], v[150:153]
    ds_read_b64 a[10:11], v244 offset:1480
    v_mfma_f32_16x16x32_bf16 v[154:157], v[178:181], v[118:121], v[154:157]
    ds_read_b128 a[32:35], v245 offset:1984
    v_mfma_f32_16x16x32_bf16 v[158:161], v[178:181], v[122:125], v[158:161]
    ds_read_b128 a[36:39], v245 offset:1472
    buffer_load_dwordx4 a[116:119], v225, s[36:39], s30 offen offset:2048 sc1
    v_mfma_f32_16x16x32_bf16 v[162:165], v[178:181], v[126:129], v[162:165]
    ds_read_b64 a[12:13], v244 offset:1984
    v_mfma_f32_16x16x32_bf16 v[166:169], v[178:181], v[130:133], v[166:169]
    ds_read_b64 a[14:15], v244 offset:1992
    v_mfma_f32_16x16x32_bf16 v[170:173], v[178:181], v[134:137], v[170:173]
    ds_read_b128 a[40:43], v245 offset:960
    v_mfma_f32_16x16x32_bf16 v[150:153], v[182:185], v[110:113], v[150:153]
    ds_read_b128 a[44:47], v245 offset:448
    v_mfma_f32_16x16x32_bf16 v[154:157], v[182:185], v[114:117], v[154:157]
    v_mfma_f32_16x16x32_bf16 v[158:161], v[182:185], v[118:121], v[158:161]
    v_mfma_f32_16x16x32_bf16 v[162:165], v[182:185], v[122:125], v[162:165]
    v_mfma_f32_16x16x32_bf16 v[166:169], v[182:185], v[126:129], v[166:169]
    buffer_load_dwordx4 a[120:123], v225, s[36:39], s30 offen offset:3072 sc1
    v_mfma_f32_16x16x32_bf16 v[170:173], v[182:185], v[130:133], v[170:173]
    v_mfma_f32_16x16x32_bf16 v[154:157], v[186:189], v[110:113], v[154:157]
    v_mfma_f32_16x16x32_bf16 v[158:161], v[186:189], v[114:117], v[158:161]
    v_mfma_f32_16x16x32_bf16 v[162:165], v[186:189], v[118:121], v[162:165]
    v_mfma_f32_16x16x32_bf16 v[166:169], v[186:189], v[122:125], v[166:169]
    v_mfma_f32_16x16x32_bf16 v[170:173], v[186:189], v[126:129], v[170:173]
    s_waitcnt lgkmcnt(0)
    v_mfma_f32_16x16x32_bf16 v[142:145], a[0:3], v[206:209], v[142:145]
    v_mfma_f32_16x16x32_bf16 v[146:149], a[0:3], v[210:213], v[146:149]
    buffer_load_dwordx4 a[124:127], v227, s[36:39], s30 offen sc1
    v_mfma_f32_16x16x32_bf16 v[146:149], a[4:7], v[206:209], v[146:149]
    v_mfma_f32_16x16x32_bf16 v[150:153], a[0:3], v[214:217], v[150:153]
    v_mfma_f32_16x16x32_bf16 v[150:153], a[4:7], v[210:213], v[150:153]
    v_mfma_f32_16x16x32_bf16 v[150:153], a[8:11], v[206:209], v[150:153]
    v_mfma_f32_16x16x32_bf16 v[154:157], a[0:3], v[218:221], v[154:157]
    v_mfma_f32_16x16x32_bf16 v[154:157], a[4:7], v[214:217], v[154:157]
    v_mfma_f32_16x16x32_bf16 v[154:157], a[8:11], v[210:213], v[154:157]
    ds_write_b128 v246, v[142:145] offset:0
    v_mfma_f32_16x16x32_bf16 v[154:157], a[12:15], v[206:209], v[154:157]
    s_add_u32 s30, s48, 81920
    buffer_load_dwordx4 a[128:131], v225, s[36:39], s30 offen offset:0 sc1
    v_mfma_f32_16x16x32_bf16 v[158:161], a[0:3], a[32:35], v[158:161]
    ds_write_b128 v246, v[146:149] offset:1024
    v_mfma_f32_16x16x32_bf16 v[158:161], a[4:7], v[218:221], v[158:161]
    v_mfma_f32_16x16x32_bf16 v[158:161], a[8:11], v[214:217], v[158:161]
    v_mfma_f32_16x16x32_bf16 v[158:161], a[12:15], v[210:213], v[158:161]
    ds_write_b128 v246, v[150:153] offset:2048
    v_mfma_f32_16x16x32_bf16 v[162:165], a[0:3], a[36:39], v[162:165]
    v_mfma_f32_16x16x32_bf16 v[162:165], a[4:7], a[32:35], v[162:165]
    v_mfma_f32_16x16x32_bf16 v[162:165], a[8:11], v[218:221], v[162:165]
    v_mfma_f32_16x16x32_bf16 v[162:165], a[12:15], v[214:217], v[162:165]
    ds_write_b128 v246, v[154:157] offset:3072
    buffer_load_dwordx4 a[132:135], v225, s[36:39], s30 offen offset:1024 sc1
    v_mfma_f32_16x16x32_bf16 v[166:169], a[0:3], a[40:43], v[166:169]
    v_mfma_f32_16x16x32_bf16 v[166:169], a[4:7], a[36:39], v[166:169]
    v_mfma_f32_16x16x32_bf16 v[166:169], a[8:11], a[32:35], v[166:169]
    v_mfma_f32_16x16x32_bf16 v[166:169], a[12:15], v[218:221], v[166:169]
    ds_write_b128 v246, v[158:161] offset:4096
    v_mfma_f32_16x16x32_bf16 v[170:173], a[0:3], a[44:47], v[170:173]
    v_mfma_f32_16x16x32_bf16 v[170:173], a[4:7], a[40:43], v[170:173]
    v_mfma_f32_16x16x32_bf16 v[170:173], a[8:11], a[36:39], v[170:173]
    v_mfma_f32_16x16x32_bf16 v[170:173], a[12:15], a[32:35], v[170:173]
    ds_write_b128 v246, v[162:165] offset:5120
    buffer_load_dwordx4 a[136:139], v225, s[36:39], s30 offen offset:2048 sc1
    s_nop 0
    ds_write_b128 v246, v[166:169] offset:6144
    s_nop 3
    ds_write_b128 v246, v[170:173] offset:7168
    s_waitcnt lgkmcnt(0)
    s_barrier
    ds_read_b128 v[78:81], v247 offset:0
    ds_read_b128 v[86:89], v247 offset:11008
    ds_read_b128 v[94:97], v247 offset:22016
    ds_read_b128 v[102:105], v247 offset:33024
    ds_read_b128 v[82:85], v247 offset:256
    ds_read_b128 v[90:93], v247 offset:11264
    ds_read_b128 v[98:101], v247 offset:22272
    ds_read_b128 v[106:109], v247 offset:33280
    s_waitcnt lgkmcnt(4)
    v_add_f32 v46, v46, v78
    v_add_f32 v47, v47, v86
    v_add_f32 v48, v48, v94
    v_add_f32 v49, v49, v102
    v_add_f32 v50, v50, v79
    v_add_f32 v51, v51, v87
    v_add_f32 v52, v52, v95
    v_add_f32_e64 v53, v53, v103
    v_cvt_pk_bf16_f32 v110, v46, v47
    v_cvt_pk_bf16_f32 v111, v48, v49
    v_cvt_pk_bf16_f32 v112, v50, v51
    v_cvt_pk_bf16_f32 v113, v52, v53
    buffer_store_dwordx4 v[110:113], v224, s[36:39], 0 offen offset:0 sc1
    v_add_f32 v54, v54, v80
    v_add_f32 v55, v55, v88
    v_add_f32 v56, v56, v96
    v_add_f32 v57, v57, v104
    v_add_f32 v58, v58, v81
    v_add_f32 v59, v59, v89
    v_add_f32 v60, v60, v97
    v_add_f32 v61, v61, v105
    v_cvt_pk_bf16_f32 v114, v54, v55
    v_cvt_pk_bf16_f32 v115, v56, v57
    v_cvt_pk_bf16_f32 v116, v58, v59
    v_cvt_pk_bf16_f32 v117, v60, v61
    buffer_store_dwordx4 v[114:117], v224, s[36:39], 0 offen offset:1024 sc1
    s_waitcnt lgkmcnt(0)
    v_add_f32 v62, v62, v82
    v_add_f32 v63, v63, v90
    v_add_f32 v64, v64, v98
    v_add_f32 v65, v65, v106
    v_add_f32 v66, v66, v83
    v_add_f32 v67, v67, v91
    v_add_f32 v68, v68, v99
    v_add_f32_e64 v69, v69, v107
    v_cvt_pk_bf16_f32 v118, v62, v63
    v_cvt_pk_bf16_f32 v119, v64, v65
    v_cvt_pk_bf16_f32 v120, v66, v67
    v_cvt_pk_bf16_f32 v121, v68, v69
    buffer_store_dwordx4 v[118:121], v224, s[36:39], 0 offen offset:2048 sc1
    v_add_f32 v70, v70, v84
    v_add_f32 v71, v71, v92
    v_add_f32 v72, v72, v100
    v_add_f32 v73, v73, v108
    v_add_f32 v74, v74, v85
    v_add_f32 v75, v75, v93
    v_add_f32 v76, v76, v101
    v_add_f32 v77, v77, v109
    v_cvt_pk_bf16_f32 v122, v70, v71
    v_cvt_pk_bf16_f32 v123, v72, v73
    v_cvt_pk_bf16_f32 v124, v74, v75
    v_cvt_pk_bf16_f32 v125, v76, v77
    buffer_store_dwordx4 v[122:125], v224, s[36:39], 0 offen offset:3072 sc1
    s_waitcnt vmcnt(12)
    v_cmp_ne_u32 vcc, s60, v10
    s_nop 0
    s_cbranch_vccnz L_fpoll1
L_fpolled1:
    s_waitcnt vmcnt(11)
    v_cmp_ne_u32 vcc, s60, v9
    s_nop 0
    s_cbranch_vccnz L_fpoll0
L_fpolled0:
    s_barrier
    buffer_store_dword v255, v45, s[36:39], 0 offen sc1
    s_add_u32 m0, s69, 0
    s_add_u32 s68, s44, 0
    s_nop 0
    buffer_load_dwordx4 v225, s[36:39], s68 offen offset:0 sc1 lds
    buffer_load_dwordx4 v225, s[36:39], s68 offen offset:1024 sc1 lds
    buffer_load_dwordx4 v225, s[36:39], s68 offen offset:2048 sc1 lds
    buffer_load_dwordx4 v225, s[36:39], s68 offen offset:3072 sc1 lds
    s_add_u32 m0, s69, 4096
    s_nop 0
    s_nop 0
    buffer_load_dwordx4 v227, s[36:39], s68 offen sc1 lds
    s_add_u32 m0, s69, 20480
    s_add_u32 s68, s44, 20480
    buffer_load_dwordx4 v225, s[36:39], s68 offen offset:0 sc1 lds
    buffer_load_dwordx4 v225, s[36:39], s68 offen offset:1024 sc1 lds
    buffer_load_dwordx4 v225, s[36:39], s68 offen offset:2048 sc1 lds
    buffer_load_dwordx4 v225, s[36:39], s68 offen offset:3072 sc1 lds
    s_add_u32 m0, s69, 24576
    s_nop 0
    buffer_load_dwordx4 v227, s[36:39], s68 offen sc1 lds
    s_branch L_mlp
L_pre:
    s_mul_i32 s64, s62, 12
    s_add_u32 s64, s64, s63
    s_sub_u32 s64, s64, 20
    s_mul_i32 s65, s62, 12
    s_add_u32 s65, s65, s63
    s_add_u32 s65, s65, 4294967276
    s_cmp_lt_u32 s62, 8
    s_cselect_b32 s64, s64, s65
    s_cmp_lt_u32 s64, 48
    s_cselect_b32 s65, 0, 48
    s_cselect_b32 s66, 0, 2048
    s_sub_u32 s65, s64, s65
    s_mul_i32 s67, s61, 491520
    s_lshl_b32 s68, s65, 6
    s_add_u32 s67, s67, s68
    v_lshrrev_b32 v16, 2, v1
    v_mul_u32_u24 v16, 3072, v16
    v_and_b32 v17, 3, v1
    v_lshl_add_u32 v16, v17, 4, v16
    s_mul_i32 s68, s61, 10240
    s_cmp_lt_u32 s64, 48
    s_waitcnt lgkmcnt(0)
    s_cselect_b32 s40, s20, s22
    s_cselect_b32 s41, s21, s23
    s_mov_b32 s42, 1966080
    s_mov_b32 s43, 0x20000
    s_mov_b32 s71, 0
    s_load_dword s60, s[30:31], s71
    s_mov_b32 s50, s67
    s_mov_b32 s51, s68
    s_mov_b32 s44, s24
    s_mov_b32 s45, s25
    s_mov_b32 s46, 1966080
    s_mov_b32 s47, 0x20000
    s_mov_b32 s36, s30
    s_mov_b32 s37, s31
    s_mov_b32 s38, 18874368
    s_mov_b32 s39, 0x20000
    s_mov_b32 s56, s26
    s_mov_b32 s57, s27
    s_mov_b32 s58, 2621440
    s_mov_b32 s59, 0x20000
    s_lshr_b32 s94, s64, 1
    s_and_b32 s95, s64, 1
    s_lshl_b32 s95, s95, 2
    s_add_u32 s95, s95, s61
    s_mul_i32 s67, s94, 40960
    s_mul_i32 s71, s95, 160
    s_add_u32 s67, s67, s71
    s_mul_i32 s68, s61, 5120
    s_add_u32 s68, s68, 40960
    v_add_u32 v17, 0, v1
    v_mul_u32_u24 v18, 6554, v17
    v_lshrrev_b32 v18, 16, v18
    v_mul_u32_u24 v19, 10, v18
    v_sub_u32 v17, v17, v19
    v_mul_u32_u24 v18, 1280, v18
    v_lshl_add_u32 v130, v17, 4, v18
    s_mov_b32 m0, s68
    s_add_u32 s68, s68, 1024
    buffer_load_dwordx4 v130, s[44:47], s67 offen lds
    v_add_u32 v17, 64, v1
    v_mul_u32_u24 v18, 6554, v17
    v_lshrrev_b32 v18, 16, v18
    v_mul_u32_u24 v19, 10, v18
    v_sub_u32 v17, v17, v19
    v_mul_u32_u24 v18, 1280, v18
    v_lshl_add_u32 v131, v17, 4, v18
    s_mov_b32 m0, s68
    s_add_u32 s68, s68, 1024
    buffer_load_dwordx4 v131, s[44:47], s67 offen lds
    v_add_u32 v17, 128, v1
    v_mul_u32_u24 v18, 6554, v17
    v_lshrrev_b32 v18, 16, v18
    v_mul_u32_u24 v19, 10, v18
    v_sub_u32 v17, v17, v19
    v_mul_u32_u24 v18, 1280, v18
    v_lshl_add_u32 v132, v17, 4, v18
    s_mov_b32 m0, s68
    s_add_u32 s68, s68, 1024
    buffer_load_dwordx4 v132, s[44:47], s67 offen lds
    v_add_u32 v17, 192, v1
    v_mul_u32_u24 v18, 6554, v17
    v_lshrrev_b32 v18, 16, v18
    v_mul_u32_u24 v19, 10, v18
    v_sub_u32 v17, v17, v19
    v_mul_u32_u24 v18, 1280, v18
    v_lshl_add_u32 v133, v17, 4, v18
    s_mov_b32 m0, s68
    s_add_u32 s68, s68, 1024
    buffer_load_dwordx4 v133, s[44:47], s67 offen lds
    v_add_u32 v17, 256, v1
    v_mul_u32_u24 v18, 6554, v17
    v_lshrrev_b32 v18, 16, v18
    v_mul_u32_u24 v19, 10, v18
    v_sub_u32 v17, v17, v19
    v_mul_u32_u24 v18, 1280, v18
    v_lshl_add_u32 v134, v17, 4, v18
    s_mov_b32 m0, s68
    s_add_u32 s68, s68, 1024
    buffer_load_dwordx4 v134, s[44:47], s67 offen lds
    s_mul_i32 s67, s65, 40960
    v_min_u32 v17, 79, v1
    s_mul_i32 s70, s61, 80
    v_add_u32 v17, s70, v17
    v_lshlrev_b32 v17, 7, v17
    buffer_load_dword v8, v17, s[40:43], s67 offen
    v_and_b32 v17, 15, v1
    v_add_u32 v17, s70, v17
    v_lshlrev_b32 v17, 7, v17
    s_add_u32 s67, s67, 8192
    buffer_load_dword v8, v17, s[40:43], s67 offen
    v_mov_b32 v23, v16
    v_mov_b32 v24, -1
    v_mov_b32 v25, -1
    v_mov_b32 v26, -1
    v_mov_b32 v27, -1
    s_lshr_b32 s70, s62, 1
    s_lshl_b32 s98, s70, 2
    s_lshr_b32 s71, s63, 3
    s_add_u32 s98, s98, s71
    s_lshl_b32 s100, s70, 3
    s_lshr_b32 s71, s63, 2
    s_add_u32 s100, s100, s71
    s_and_b32 s70, s62, 1
    s_lshl_b32 s99, s70, 3
    s_and_b32 s71, s63, 7
    s_add_u32 s99, s99, s71
    s_lshl_b32 s101, s70, 2
    s_and_b32 s71, s63, 3
    s_add_u32 s101, s101, s71
    s_lshl_b32 s70, s98, 3
    s_lshl_b32 s71, s61, 1
    s_add_u32 s70, s70, s71
    s_mul_i32 s70, s70, 49152
    s_lshl_b32 s71, s99, 10
    s_add_u32 s70, s70, s71
    s_add_u32 s3, s70, 4194304
    v_add_u32 v227, 4096, v225
    v_min_u32 v226, 39, v1
    s_mul_i32 s70, s61, 40
    v_add_u32 v226, s70, v226
    v_lshlrev_b32 v226, 7, v226
    v_add_u32 v226, 36864, v226
    v_min_u32 v253, 47, v1
    v_lshlrev_b32 v253, 8, v253
    s_lshr_b32 s70, s101, 2
    s_lshl_b32 s70, s70, 7
    s_add_u32 s70, s70, 20480
    v_add_u32 v253, s70, v253
    v_and_b32 v254, 1, v1
    v_mul_u32_u24 v254, 48, v254
    v_min_u32 v255, 5, v1
    v_lshrrev_b32 v255, 1, v255
    v_add_u32 v254, v254, v255
    s_mul_i32 s70, s99, 3
    v_add_u32 v254, s70, v254
    v_lshlrev_b32 v254, 7, v254
    v_add_u32 v254, 4096, v254
    s_add_u32 s70, s61, 1
    s_and_b32 s70, s70, 3
    s_mul_i32 s70, s70, 49152
    v_add_u32 v228, s70, v225
    s_add_u32 s70, s61, 2
    s_and_b32 s70, s70, 3
    s_mul_i32 s70, s70, 49152
    v_add_u32 v229, s70, v225
    s_add_u32 s70, s61, 3
    s_and_b32 s70, s70, 3
    s_mul_i32 s70, s70, 49152
    v_add_u32 v230, s70, v225
    s_add_u32 s70, s61, 4
    s_and_b32 s70, s70, 3
    s_mul_i32 s70, s70, 49152
    v_add_u32 v231, s70, v225
    v_lshrrev_b32 v16, 4, v1
    v_bfe_u32 v18, v1, 2, 2
    v_and_b32 v17, 3, v1
    v_lshl_add_u32 v16, v16, 2, v18
    v_lshlrev_b32 v21, 6, v16
    v_lshl_add_u32 v21, v17, 3, v21
    s_mul_i32 s68, s61, 10240
    v_add_u32 v21, s68, v21
    v_mul_u32_u24 v22, 160, v16
    v_lshl_add_u32 v22, v17, 3, v22
    s_mul_i32 s68, s61, 5120
    s_add_u32 s68, s68, 40960
    v_add_u32 v22, s68, v22
    s_mov_b32 s92, 0x3f803f80
    s_mov_b32 s93, 0xffff0000
    v_and_b32 v17, 15, v1
    v_lshrrev_b32 v16, 4, v0
    v_lshlrev_b32 v16, 7, v16
    v_lshl_add_u32 v16, v17, 2, v16
    v_add_u32 v16, 65536, v16
    v_lshlrev_b32 v17, 2, v17
    v_add_u32 v17, 65536, v17
    v_add_u32 v18, 1024, v17
    s_mul_i32 s67, s65, 43
    s_lshr_b32 s67, s67, 7
    s_mul_i32 s68, s67, 3
    s_sub_u32 s68, s65, s68
    s_mul_i32 s67, s67, 245760
    s_cmp_eq_u32 s68, 2
    s_cselect_b32 s49, 1, 2
    s_cselect_b32 s68, 40, s68
    s_lshl_b32 s49, s49, 12
    s_lshl_b32 s68, s68, 12
    s_add_u32 s67, s67, s68
    s_add_u32 s67, s67, s66
    s_mul_i32 s68, s61, 5
    s_mul_i32 s68, s68, s49
    s_add_u32 s67, s67, s68
    s_add_u32 s67, s67, 11534336
    s_mul_i32 s70, s94, 43
    s_lshr_b32 s70, s70, 7
    s_mul_i32 s68, s70, 3
    s_sub_u32 s68, s94, s68
    s_lshl_b32 s68, s68, 4
    s_add_u32 s70, s70, s68
    s_mul_i32 s70, s70, 5120
    s_mul_i32 s68, s95, 245760
    s_add_u32 s70, s70, s68
    s_add_u32 s97, s70, 15728640
    s_waitcnt lgkmcnt(0)
    s_add_u32 s60, s60, 0x9e3779b9
    s_lshl_b32 s70, s64, 7
    v_mov_b32 v12, s70
    v_cmp_eq_u32 vcc, 0, v0
    v_mov_b32 v13, s60
    s_mov_b32 s71, 20480
    v_cndmask_b32 v12, -1, v12, vcc
    s_lshl_b32 s70, s98, 4
    s_add_u32 s70, s70, s99
    s_lshl_b32 s70, s70, 7
    s_add_u32 s70, s70, 65536
    v_mov_b32 v19, s70
    v_cndmask_b32 v19, -1, v19, vcc
    s_sub_u32 s70, s63, 20
    s_lshl_b32 s70, s70, 2
    s_add_u32 s70, s70, s61
    s_and_b32 s68, s62, 1
    v_lshlrev_b32 v128, 7, v1
    s_mul_i32 s52, s70, 24576
    v_add_u32 v129, s52, v128
    s_mul_i32 s52, s68, 983040
    s_add_u32 s52, s52, 15728640
    s_mul_i32 s53, s70, 43
    s_lshr_b32 s53, s53, 8
    s_mul_i32 s54, s53, 6
    s_sub_u32 s54, s70, s54
    s_mul_i32 s53, s53, 245760
    s_lshl_b32 s54, s54, 13
    s_add_u32 s53, s53, s54
    s_mul_i32 s54, s68, 1966080
    s_add_u32 s53, s53, s54
    s_add_u32 s64, s53, 11534336
    v_min_u32 v135, 47, v1
    v_cmp_gt_u32 vcc, 24, v135
    s_mul_i32 s54, s68, 24
    v_add_u32 v136, 24, v135
    v_cndmask_b32 v135, v136, v135, vcc
    v_add_u32 v135, s54, v135
    v_lshlrev_b32 v135, 7, v135
    v_add_u32 v135, 4096, v135
    s_mov_b32 s65, 0
    s_waitcnt vmcnt(2)
    s_nop 0
    ds_read_b64_tr_b16 v[104:105], v22 offset:0
    ds_read_b64_tr_b16 v[106:107], v22 offset:2560
    ds_read_b64_tr_b16 v[108:109], v22 offset:32
    ds_read_b64_tr_b16 v[110:111], v22 offset:2592
    ds_read_b64_tr_b16 v[112:113], v22 offset:64
    ds_read_b64_tr_b16 v[114:115], v22 offset:2624
    ds_read_b64_tr_b16 v[116:117], v22 offset:96
    ds_read_b64_tr_b16 v[118:119], v22 offset:2656
    ds_read_b64_tr_b16 v[120:121], v22 offset:128
    ds_read_b64_tr_b16 v[122:123], v22 offset:2688
    s_waitcnt lgkmcnt(0)
    s_nop 0
    buffer_store_dwordx4 v[104:107], v225, s[36:39], s97 offen offset:0 sc1
    buffer_store_dwordx4 v[108:111], v225, s[36:39], s97 offen offset:1024 sc1
    buffer_store_dwordx4 v[112:115], v225, s[36:39], s97 offen offset:2048 sc1
    buffer_store_dwordx4 v[116:119], v225, s[36:39], s97 offen offset:3072 sc1
    buffer_store_dwordx4 v[120:123], v227, s[36:39], s97 offen sc1
    s_mov_b32 m0, s51
    s_add_u32 s51, s51, 1024
    buffer_load_dwordx4 v23, s[40:43], s50 offen lds
    s_add_u32 s50, s50, 49152
    s_mov_b32 m0, s51
    s_add_u32 s51, s51, 1024
    buffer_load_dwordx4 v23, s[40:43], s50 offen lds
    s_add_u32 s50, s50, 49152
    s_mov_b32 m0, s51
    s_add_u32 s51, s51, 1024
    buffer_load_dwordx4 v23, s[40:43], s50 offen lds
    s_add_u32 s50, s50, 49152
    s_mov_b32 m0, s51
    s_add_u32 s51, s51, 1024
    buffer_load_dwordx4 v23, s[40:43], s50 offen lds
    s_add_u32 s50, s50, 49152
    s_waitcnt vmcnt(4)
    s_barrier
    buffer_store_dword v13, v12, s[36:39], s71 offen sc1
    s_mov_b32 m0, s51
    s_add_u32 s51, s51, 1024
    buffer_load_dwordx4 v23, s[40:43], s50 offen lds
    s_add_u32 s50, s50, 49152
    s_mov_b32 m0, s51
    s_add_u32 s51, s51, 1024
    buffer_load_dwordx4 v23, s[40:43], s50 offen lds
    s_add_u32 s50, s50, 49152
    s_mov_b32 m0, s51
    s_add_u32 s51, s51, 1024
    buffer_load_dwordx4 v23, s[40:43], s50 offen lds
    s_add_u32 s50, s50, 49152
    s_mov_b32 m0, s51
    s_add_u32 s51, s51, 1024
    buffer_load_dwordx4 v23, s[40:43], s50 offen lds
    s_add_u32 s50, s50, 49152
    s_mov_b32 m0, s51
    s_add_u32 s51, s51, 1024
    buffer_load_dwordx4 v23, s[40:43], s50 offen lds
    s_add_u32 s50, s50, 49152
    s_mov_b32 m0, s51
    s_add_u32 s51, s51, 1024
    buffer_load_dwordx4 v23, s[40:43], s50 offen lds
    s_add_u32 s50, s50, 49152
    s_waitcnt vmcnt(0)
    s_nop 0
    ds_read_b64_tr_b16 v[32:33], v21 offset:0
    ds_read_b64_tr_b16 v[34:35], v21 offset:1024
    ds_read_b64_tr_b16 v[36:37], v21 offset:32
    ds_read_b64_tr_b16 v[38:39], v21 offset:1056
    ds_read_b64_tr_b16 v[40:41], v21 offset:2048
    ds_read_b64_tr_b16 v[42:43], v21 offset:3072
    ds_read_b64_tr_b16 v[44:45], v21 offset:2080
    ds_read_b64_tr_b16 v[46:47], v21 offset:3104
    ds_read_b64_tr_b16 v[48:49], v21 offset:4096
    ds_read_b64_tr_b16 v[50:51], v21 offset:5120
    ds_read_b64_tr_b16 v[52:53], v21 offset:4128
    ds_read_b64_tr_b16 v[54:55], v21 offset:5152
    ds_read_b64_tr_b16 v[56:57], v21 offset:6144
    ds_read_b64_tr_b16 v[58:59], v21 offset:7168
    s_waitcnt lgkmcnt(12)
    s_nop 0
    ds_read_b64_tr_b16 v[60:61], v21 offset:6176
    ds_read_b64_tr_b16 v[62:63], v21 offset:7200
    ds_read_b64_tr_b16 v[64:65], v21 offset:8192
    ds_read_b64_tr_b16 v[66:67], v21 offset:9216
    ds_read_b64_tr_b16 v[68:69], v21 offset:8224
    ds_read_b64_tr_b16 v[70:71], v21 offset:9248
    v_dot2_f32_bf16 v14, v32, s92, 0
    v_dot2_f32_bf16 v14, v33, s92, v14
    v_dot2_f32_bf16 v14, v34, s92, v14
    v_dot2_f32_bf16 v14, v35, s92, v14
    s_waitcnt lgkmcnt(15)
    v_dot2_f32_bf16 v15, v36, s92, 0
    v_dot2_f32_bf16 v15, v37, s92, v15
    v_dot2_f32_bf16 v15, v38, s92, v15
    v_dot2_f32_bf16 v15, v39, s92, v15
    s_waitcnt lgkmcnt(14)
    v_dot2_f32_bf16 v14, v40, s92, v14
    v_dot2_f32_bf16 v14, v41, s92, v14
    v_dot2_f32_bf16 v14, v42, s92, v14
    v_dot2_f32_bf16 v14, v43, s92, v14
    s_waitcnt lgkmcnt(12)
    v_dot2_f32_bf16 v15, v44, s92, v15
    v_dot2_f32_bf16 v15, v45, s92, v15
    v_dot2_f32_bf16 v15, v46, s92, v15
    v_dot2_f32_bf16 v15, v47, s92, v15
    s_waitcnt lgkmcnt(10)
    v_dot2_f32_bf16 v14, v48, s92, v14
    v_dot2_f32_bf16 v14, v49, s92, v14
    v_dot2_f32_bf16 v14, v50, s92, v14
    v_dot2_f32_bf16 v14, v51, s92, v14
    s_waitcnt lgkmcnt(8)
    v_dot2_f32_bf16 v15, v52, s92, v15
    v_dot2_f32_bf16 v15, v53, s92, v15
    v_dot2_f32_bf16 v15, v54, s92, v15
    v_dot2_f32_bf16 v15, v55, s92, v15
    s_waitcnt lgkmcnt(6)
    v_dot2_f32_bf16 v14, v56, s92, v14
    v_dot2_f32_bf16 v14, v57, s92, v14
    v_dot2_f32_bf16 v14, v58, s92, v14
    v_dot2_f32_bf16 v14, v59, s92, v14
    s_waitcnt lgkmcnt(4)
    v_dot2_f32_bf16 v15, v60, s92, v15
    v_dot2_f32_bf16 v15, v61, s92, v15
    v_dot2_f32_bf16 v15, v62, s92, v15
    v_dot2_f32_bf16 v15, v63, s92, v15
    s_waitcnt lgkmcnt(2)
    v_dot2_f32_bf16 v14, v64, s92, v14
    v_dot2_f32_bf16 v14, v65, s92, v14
    v_dot2_f32_bf16 v14, v66, s92, v14
    v_dot2_f32_bf16 v14, v67, s92, v14
    s_waitcnt lgkmcnt(0)
    v_dot2_f32_bf16 v15, v68, s92, v15
    v_dot2_f32_bf16 v15, v69, s92, v15
    v_dot2_f32_bf16 v15, v70, s92, v15
    v_dot2_f32_bf16 v15, v71, s92, v15
    s_nop 2
    ds_write2_b32 v16, v14, v15 offset0:0 offset1:16
    s_waitcnt lgkmcnt(0)
    s_barrier
    ds_read2_b32 v[72:73], v17 offset0:0 offset1:16
    ds_read2_b32 v[74:75], v17 offset0:32 offset1:48
    ds_read2_b32 v[76:77], v17 offset0:64 offset1:80
    ds_read2_b32 v[78:79], v17 offset0:96 offset1:112
    ds_read2_b32 v[80:81], v17 offset0:128 offset1:144
    ds_read2_b32 v[82:83], v17 offset0:160 offset1:176
    ds_read2_b32 v[84:85], v17 offset0:192 offset1:208
    ds_read2_b32 v[86:87], v17 offset0:224 offset1:240
    ds_read2_b32 v[88:89], v18 offset0:0 offset1:16
    ds_read2_b32 v[90:91], v18 offset0:32 offset1:48
    ds_read2_b32 v[92:93], v18 offset0:64 offset1:80
    ds_read2_b32 v[94:95], v18 offset0:96 offset1:112
    ds_read2_b32 v[96:97], v18 offset0:128 offset1:144
    ds_read2_b32 v[98:99], v18 offset0:160 offset1:176
    ds_read2_b32 v[100:101], v18 offset0:192 offset1:208
    ds_read2_b32 v[102:103], v18 offset0:224 offset1:240
    s_mov_b32 s92, 0x3f80
    s_mov_b32 s93, 0x3f800000
    s_waitcnt lgkmcnt(0)
    v_pk_add_f32 v[72:73], v[72:73], v[88:89]
    v_pk_add_f32 v[74:75], v[74:75], v[90:91]
    v_pk_add_f32 v[76:77], v[76:77], v[92:93]
    v_pk_add_f32 v[78:79], v[78:79], v[94:95]
    v_pk_add_f32 v[80:81], v[80:81], v[96:97]
    v_pk_add_f32 v[82:83], v[82:83], v[98:99]
    v_pk_add_f32 v[84:85], v[84:85], v[100:101]
    v_pk_add_f32 v[86:87], v[86:87], v[102:103]
    v_pk_add_f32 v[72:73], v[72:73], v[80:81]
    v_pk_add_f32 v[74:75], v[74:75], v[82:83]
    v_pk_add_f32 v[76:77], v[76:77], v[84:85]
    v_pk_add_f32 v[78:79], v[78:79], v[86:87]
    v_pk_add_f32 v[72:73], v[72:73], v[76:77]
    v_pk_add_f32 v[74:75], v[74:75], v[78:79]
    v_pk_add_f32 v[72:73], v[72:73], v[74:75]
    v_mul_f32 v72, 0xbacccccd, v72
    v_mul_f32 v73, 0xbacccccd, v73
    v_dot2_f32_bf16 v76, v32, s92, v72
    v_dot2_f32_bf16 v77, v32, s93, v72
    v_dot2_f32_bf16 v78, v33, s92, v72
    v_dot2_f32_bf16 v79, v33, s93, v72
    v_dot2_f32_bf16 v80, v34, s92, v72
    v_dot2_f32_bf16 v81, v34, s93, v72
    v_dot2_f32_bf16 v82, v35, s92, v72
    v_dot2_f32_bf16 v83, v35, s93, v72
    v_cvt_pk_bf16_f32 v32, v76, v77
    v_cvt_pk_bf16_f32 v33, v78, v79
    v_cvt_pk_bf16_f32 v34, v80, v81
    v_cvt_pk_bf16_f32 v35, v82, v83
    buffer_store_dwordx4 v[32:35], v225, s[36:39], s67 offen offset:0 sc1
    v_dot2_f32_bf16 v76, v36, s92, v73
    v_dot2_f32_bf16 v77, v36, s93, v73
    v_dot2_f32_bf16 v78, v37, s92, v73
    v_dot2_f32_bf16 v79, v37, s93, v73
    v_dot2_f32_bf16 v80, v38, s92, v73
    v_dot2_f32_bf16 v81, v38, s93, v73
    v_dot2_f32_bf16 v82, v39, s92, v73
    v_dot2_f32_bf16 v83, v39, s93, v73
    v_cvt_pk_bf16_f32 v36, v76, v77
    v_cvt_pk_bf16_f32 v37, v78, v79
    v_cvt_pk_bf16_f32 v38, v80, v81
    v_cvt_pk_bf16_f32 v39, v82, v83
    buffer_store_dwordx4 v[36:39], v225, s[36:39], s67 offen offset:1024 sc1
    s_add_u32 s67, s67, s49
    s_nop 0
    v_dot2_f32_bf16 v76, v40, s92, v72
    v_dot2_f32_bf16 v77, v40, s93, v72
    v_dot2_f32_bf16 v78, v41, s92, v72
    v_dot2_f32_bf16 v79, v41, s93, v72
    v_dot2_f32_bf16 v80, v42, s92, v72
    v_dot2_f32_bf16 v81, v42, s93, v72
    v_dot2_f32_bf16 v82, v43, s92, v72
    v_dot2_f32_bf16 v83, v43, s93, v72
    v_cvt_pk_bf16_f32 v40, v76, v77
    v_cvt_pk_bf16_f32 v41, v78, v79
    v_cvt_pk_bf16_f32 v42, v80, v81
    v_cvt_pk_bf16_f32 v43, v82, v83
    buffer_store_dwordx4 v[40:43], v225, s[36:39], s67 offen offset:0 sc1
    v_dot2_f32_bf16 v76, v44, s92, v73
    v_dot2_f32_bf16 v77, v44, s93, v73
    v_dot2_f32_bf16 v78, v45, s92, v73
    v_dot2_f32_bf16 v79, v45, s93, v73
    v_dot2_f32_bf16 v80, v46, s92, v73
    v_dot2_f32_bf16 v81, v46, s93, v73
    v_dot2_f32_bf16 v82, v47, s92, v73
    v_dot2_f32_bf16 v83, v47, s93, v73
    v_cvt_pk_bf16_f32 v44, v76, v77
    v_cvt_pk_bf16_f32 v45, v78, v79
    v_cvt_pk_bf16_f32 v46, v80, v81
    v_cvt_pk_bf16_f32 v47, v82, v83
    buffer_store_dwordx4 v[44:47], v225, s[36:39], s67 offen offset:1024 sc1
    s_add_u32 s67, s67, s49
    s_nop 0
    v_dot2_f32_bf16 v76, v48, s92, v72
    v_dot2_f32_bf16 v77, v48, s93, v72
    v_dot2_f32_bf16 v78, v49, s92, v72
    v_dot2_f32_bf16 v79, v49, s93, v72
    v_dot2_f32_bf16 v80, v50, s92, v72
    v_dot2_f32_bf16 v81, v50, s93, v72
    v_dot2_f32_bf16 v82, v51, s92, v72
    v_dot2_f32_bf16 v83, v51, s93, v72
    v_cvt_pk_bf16_f32 v48, v76, v77
    v_cvt_pk_bf16_f32 v49, v78, v79
    v_cvt_pk_bf16_f32 v50, v80, v81
    v_cvt_pk_bf16_f32 v51, v82, v83
    buffer_store_dwordx4 v[48:51], v225, s[36:39], s67 offen offset:0 sc1
    v_dot2_f32_bf16 v76, v52, s92, v73
    v_dot2_f32_bf16 v77, v52, s93, v73
    v_dot2_f32_bf16 v78, v53, s92, v73
    v_dot2_f32_bf16 v79, v53, s93, v73
    v_dot2_f32_bf16 v80, v54, s92, v73
    v_dot2_f32_bf16 v81, v54, s93, v73
    v_dot2_f32_bf16 v82, v55, s92, v73
    v_dot2_f32_bf16 v83, v55, s93, v73
    v_cvt_pk_bf16_f32 v52, v76, v77
    v_cvt_pk_bf16_f32 v53, v78, v79
    v_cvt_pk_bf16_f32 v54, v80, v81
    v_cvt_pk_bf16_f32 v55, v82, v83
    buffer_store_dwordx4 v[52:55], v225, s[36:39], s67 offen offset:1024 sc1
    s_add_u32 s67, s67, s49
    s_nop 0
    v_dot2_f32_bf16 v76, v56, s92, v72
    v_dot2_f32_bf16 v77, v56, s93, v72
    v_dot2_f32_bf16 v78, v57, s92, v72
    v_dot2_f32_bf16 v79, v57, s93, v72
    v_dot2_f32_bf16 v80, v58, s92, v72
    v_dot2_f32_bf16 v81, v58, s93, v72
    v_dot2_f32_bf16 v82, v59, s92, v72
    v_dot2_f32_bf16 v83, v59, s93, v72
    v_cvt_pk_bf16_f32 v56, v76, v77
    v_cvt_pk_bf16_f32 v57, v78, v79
    v_cvt_pk_bf16_f32 v58, v80, v81
    v_cvt_pk_bf16_f32 v59, v82, v83
    buffer_store_dwordx4 v[56:59], v225, s[36:39], s67 offen offset:0 sc1
    v_dot2_f32_bf16 v76, v60, s92, v73
    v_dot2_f32_bf16 v77, v60, s93, v73
    v_dot2_f32_bf16 v78, v61, s92, v73
    v_dot2_f32_bf16 v79, v61, s93, v73
    v_dot2_f32_bf16 v80, v62, s92, v73
    v_dot2_f32_bf16 v81, v62, s93, v73
    v_dot2_f32_bf16 v82, v63, s92, v73
    v_dot2_f32_bf16 v83, v63, s93, v73
    v_cvt_pk_bf16_f32 v60, v76, v77
    v_cvt_pk_bf16_f32 v61, v78, v79
    v_cvt_pk_bf16_f32 v62, v80, v81
    v_cvt_pk_bf16_f32 v63, v82, v83
    buffer_store_dwordx4 v[60:63], v225, s[36:39], s67 offen offset:1024 sc1
    s_add_u32 s67, s67, s49
    s_nop 0
    v_dot2_f32_bf16 v76, v64, s92, v72
    v_dot2_f32_bf16 v77, v64, s93, v72
    v_dot2_f32_bf16 v78, v65, s92, v72
    v_dot2_f32_bf16 v79, v65, s93, v72
    v_dot2_f32_bf16 v80, v66, s92, v72
    v_dot2_f32_bf16 v81, v66, s93, v72
    v_dot2_f32_bf16 v82, v67, s92, v72
    v_dot2_f32_bf16 v83, v67, s93, v72
    v_cvt_pk_bf16_f32 v64, v76, v77
    v_cvt_pk_bf16_f32 v65, v78, v79
    v_cvt_pk_bf16_f32 v66, v80, v81
    v_cvt_pk_bf16_f32 v67, v82, v83
    buffer_store_dwordx4 v[64:67], v225, s[36:39], s67 offen offset:0 sc1
    v_dot2_f32_bf16 v76, v68, s92, v73
    v_dot2_f32_bf16 v77, v68, s93, v73
    v_dot2_f32_bf16 v78, v69, s92, v73
    v_dot2_f32_bf16 v79, v69, s93, v73
    v_dot2_f32_bf16 v80, v70, s92, v73
    v_dot2_f32_bf16 v81, v70, s93, v73
    v_dot2_f32_bf16 v82, v71, s92, v73
    v_dot2_f32_bf16 v83, v71, s93, v73
    v_cvt_pk_bf16_f32 v68, v76, v77
    v_cvt_pk_bf16_f32 v69, v78, v79
    v_cvt_pk_bf16_f32 v70, v80, v81
    v_cvt_pk_bf16_f32 v71, v82, v83
    buffer_store_dwordx4 v[68:71], v225, s[36:39], s67 offen offset:1024 sc1
    s_add_u32 s67, s67, s49
    s_mul_i32 s69, s61, 5120
    s_mul_i32 s68, s99, 245760
    s_add_u32 s68, s68, 11534336
    s_add_u32 s68, s68, s69
    s_mul_i32 s30, s101, 245760
    s_add_u32 s30, s30, 15728640
    s_add_u32 s30, s30, s69
    s_lshl_b32 s28, s98, 10
    s_lshl_b32 s29, s61, 8
    s_add_u32 s28, s28, s29
    s_add_u32 s28, s28, 1048576
    s_mul_i32 s29, s100, 196608
    s_lshl_b32 s31, s61, 10
    s_add_u32 s29, s29, s31
    s_add_u32 s29, s29, 4194304
    s_add_u32 s31, s98, s99
    s_and_b32 s31, s31, 0
    s_add_u32 s31, s31, 0
    s_and_b32 s31, s31, 3
    s_mul_i32 s40, s31, 655360
    s_add_u32 s40, s40, s28
    s_mul_i32 s44, s31, 40960
    s_add_u32 s44, s44, s68
    s_mul_i32 s20, s31, 20480
    s_add_u32 s20, s20, s68
    s_add_u32 s31, s100, s101
    s_and_b32 s31, s31, 0
    s_add_u32 s31, s31, 0
    s_and_b32 s31, s31, 3
    s_mul_i32 s48, s31, 20480
    s_add_u32 s48, s48, s30
    s_lshl_b32 s52, s31, 12
    s_add_u32 s52, s52, s29
    s_add_u32 s31, s98, s99
    s_and_b32 s31, s31, 0
    s_add_u32 s31, s31, 1
    s_and_b32 s31, s31, 3
    s_mul_i32 s41, s31, 655360
    s_add_u32 s41, s41, s28
    s_mul_i32 s45, s31, 40960
    s_add_u32 s45, s45, s68
    s_mul_i32 s21, s31, 20480
    s_add_u32 s21, s21, s68
    s_add_u32 s31, s100, s101
    s_and_b32 s31, s31, 0
    s_add_u32 s31, s31, 1
    s_and_b32 s31, s31, 3
    s_mul_i32 s49, s31, 20480
    s_add_u32 s49, s49, s30
    s_lshl_b32 s53, s31, 12
    s_add_u32 s53, s53, s29
    s_add_u32 s31, s98, s99
    s_and_b32 s31, s31, 0
    s_add_u32 s31, s31, 2
    s_and_b32 s31, s31, 3
    s_mul_i32 s42, s31, 655360
    s_add_u32 s42, s42, s28
    s_mul_i32 s46, s31, 40960
    s_add_u32 s46, s46, s68
    s_mul_i32 s22, s31, 20480
    s_add_u32 s22, s22, s68
    s_add_u32 s31, s100, s101
    s_and_b32 s31, s31, 0
    s_add_u32 s31, s31, 2
    s_and_b32 s31, s31, 3
    s_mul_i32 s50, s31, 20480
    s_add_u32 s50, s50, s30
    s_lshl_b32 s54, s31, 12
    s_add_u32 s54, s54, s29
    s_add_u32 s31, s98, s99
    s_and_b32 s31, s31, 0
    s_add_u32 s31, s31, 3
    s_and_b32 s31, s31, 3
    s_mul_i32 s43, s31, 655360
    s_add_u32 s43, s43, s28
    s_mul_i32 s47, s31, 40960
    s_add_u32 s47, s47, s68
    s_mul_i32 s23, s31, 20480
    s_add_u32 s23, s23, s68
    s_add_u32 s31, s100, s101
    s_and_b32 s31, s31, 0
    s_add_u32 s31, s31, 3
    s_and_b32 s31, s31, 3
    s_mul_i32 s51, s31, 20480
    s_add_u32 s51, s51, s30
    s_lshl_b32 s55, s31, 12
    s_add_u32 s55, s55, s29
    s_add_u32 s28, s3, 0
    s_nop 0
    buffer_store_dwordx4 v[24:27], v225, s[36:39], s28 offen sc1
    s_add_u32 s28, s3, 49152
    buffer_store_dwordx4 v[24:27], v225, s[36:39], s28 offen sc1
    s_add_u32 s28, s3, 16384
    buffer_store_dwordx4 v[24:27], v225, s[36:39], s28 offen sc1
    s_add_u32 s28, s3, 65536
    buffer_store_dwordx4 v[24:27], v225, s[36:39], s28 offen sc1
    s_add_u32 s28, s3, 32768
    buffer_store_dwordx4 v[24:27], v225, s[36:39], s28 offen sc1
    s_add_u32 s28, s3, 81920
    buffer_store_dwordx4 v[24:27], v225, s[36:39], s28 offen sc1
    buffer_load_dword v8, v253, s[36:39], 0 offen sc1
    s_mov_b32 s71, 4096
    s_waitcnt vmcnt(7)
    s_barrier
    buffer_store_dword v13, v12, s[36:39], s71 offen sc1
    s_waitcnt vmcnt(1)
    s_barrier
    buffer_store_dword v13, v19, s[36:39], 0 offen sc1
    v_cmp_ne_u32 vcc, s60, v8
    s_nop 0
    s_cbranch_vccnz L_pd
L_pd_ok:
    s_add_u32 s30, s48, 0
    buffer_load_dwordx4 a[48:51], v225, s[36:39], s30 offen offset:0 sc1
    buffer_load_dwordx4 a[52:55], v225, s[36:39], s30 offen offset:1024 sc1
    buffer_load_dwordx4 a[56:59], v225, s[36:39], s30 offen offset:2048 sc1
    buffer_load_dwordx4 a[60:63], v225, s[36:39], s30 offen offset:3072 sc1
    buffer_load_dwordx4 a[64:67], v227, s[36:39], s30 offen sc1
    s_add_u32 s30, s49, 0
    s_nop 0
    buffer_load_dwordx4 a[68:71], v225, s[36:39], s30 offen offset:0 sc1
    buffer_load_dwordx4 a[72:75], v225, s[36:39], s30 offen offset:1024 sc1
    buffer_load_dwordx4 a[76:79], v225, s[36:39], s30 offen offset:2048 sc1
    buffer_load_dwordx4 a[80:83], v225, s[36:39], s30 offen offset:3072 sc1
    buffer_load_dwordx4 a[84:87], v227, s[36:39], s30 offen sc1
    buffer_load_dword v7, v135, s[36:39], 0 offen sc1
    s_waitcnt vmcnt(0)
    v_cmp_ne_u32 vcc, s60, v7
    s_nop 0
    s_cbranch_vccnz L_pw
L_pw_ok:
    s_add_u32 s30, s50, 0
    s_nop 0
    buffer_load_dwordx4 a[88:91], v225, s[36:39], s30 offen offset:0 sc1
    buffer_load_dwordx4 a[92:95], v225, s[36:39], s30 offen offset:1024 sc1
    buffer_load_dwordx4 a[96:99], v225, s[36:39], s30 offen offset:2048 sc1
    buffer_load_dwordx4 a[100:103], v225, s[36:39], s30 offen offset:3072 sc1
    buffer_load_dwordx4 a[104:107], v227, s[36:39], s30 offen sc1
    s_add_u32 s30, s51, 0
    s_nop 0
    buffer_load_dwordx4 a[108:111], v225, s[36:39], s30 offen offset:0 sc1
    buffer_load_dwordx4 a[112:115], v225, s[36:39], s30 offen offset:1024 sc1
    buffer_load_dwordx4 a[116:119], v225, s[36:39], s30 offen offset:2048 sc1
    buffer_load_dwordx4 a[120:123], v225, s[36:39], s30 offen offset:3072 sc1
    buffer_load_dwordx4 a[124:127], v227, s[36:39], s30 offen sc1
    s_add_u32 s30, s48, 81920
    buffer_load_dwordx4 a[128:131], v225, s[36:39], s30 offen offset:0 sc1
    buffer_load_dwordx4 a[132:135], v225, s[36:39], s30 offen offset:1024 sc1
    buffer_load_dwordx4 a[136:139], v225, s[36:39], s30 offen offset:2048 sc1
    s_add_u32 m0, s69, 0
    s_add_u32 s68, s44, 0
    buffer_load_dwordx4 v225, s[36:39], s68 offen offset:0 sc1 lds
    buffer_load_dwordx4 v225, s[36:39], s68 offen offset:1024 sc1 lds
    buffer_load_dwordx4 v225, s[36:39], s68 offen offset:2048 sc1 lds
    buffer_load_dwordx4 v225, s[36:39], s68 offen offset:3072 sc1 lds
    s_add_u32 m0, s69, 4096
    s_nop 0
    s_nop 0
    buffer_load_dwordx4 v227, s[36:39], s68 offen sc1 lds
    s_add_u32 m0, s69, 20480
    s_add_u32 s68, s44, 20480
    buffer_load_dwordx4 v225, s[36:39], s68 offen offset:0 sc1 lds
    buffer_load_dwordx4 v225, s[36:39], s68 offen offset:1024 sc1 lds
    buffer_load_dwordx4 v225, s[36:39], s68 offen offset:2048 sc1 lds
    buffer_load_dwordx4 v225, s[36:39], s68 offen offset:3072 sc1 lds
    s_add_u32 m0, s69, 24576
    s_nop 0
    buffer_load_dwordx4 v227, s[36:39], s68 offen sc1 lds
    buffer_load_dword v9, v226, s[36:39], 0 offen sc1
    s_waitcnt vmcnt(0)
    v_cmp_ne_u32 vcc, s60, v9
    s_nop 0
    s_cbranch_vccnz L_ph
L_ph_ok:
    s_barrier
    s_waitcnt vmcnt(0)
    v_mov_b32 v45, v19
L_mlp:
    v_lshrrev_b32 v224, 4, v225
    v_lshrrev_b32 v232, 4, v224
    v_and_b32 v233, 15, v224
    v_lshlrev_b32 v233, 4, v233
    v_lshl_add_u32 v232, v232, 14, v233
    v_add_u32 v233, 65536, v232
    s_add_u32 s28, s40, 0
    s_nop 0
    buffer_load_dwordx4 v[0:3], v232, s[36:39], s28 offen sc1
    buffer_load_dwordx4 v[4:7], v233, s[36:39], s28 offen sc1
    s_add_u32 s28, s40, 131072
    buffer_load_dwordx4 v[8:11], v232, s[36:39], s28 offen sc1
    buffer_load_dwordx4 v[12:15], v233, s[36:39], s28 offen sc1
    v_add_u32 v234, 65536, v225
    v_add_u32 v235, 131072, v225
    s_mov_b32 s65, 0
    s_mov_b32 s92, -1
    s_mov_b32 s93, 0xffff0000
    s_add_u32 s31, s3, 49152
    v_min_u32 v226, 15, v224
    s_lshl_b32 s71, s98, 4
    v_add_u32 v226, s71, v226
    v_lshlrev_b32 v226, 7, v226
    v_add_u32 v226, 65536, v226
    s_add_u32 m0, s69, 40960
    s_add_u32 s68, s45, 0
    s_nop 0
    buffer_load_dwordx4 v225, s[36:39], s68 offen offset:0 sc1 lds
    buffer_load_dwordx4 v225, s[36:39], s68 offen offset:1024 sc1 lds
    buffer_load_dwordx4 v225, s[36:39], s68 offen offset:2048 sc1 lds
    buffer_load_dwordx4 v225, s[36:39], s68 offen offset:3072 sc1 lds
    s_add_u32 m0, s69, 45056
    s_nop 0
    s_nop 0
    buffer_load_dwordx4 v227, s[36:39], s68 offen sc1 lds
    s_add_u32 m0, s69, 61440
    s_add_u32 s68, s45, 20480
    buffer_load_dwordx4 v225, s[36:39], s68 offen offset:0 sc1 lds
    buffer_load_dwordx4 v225, s[36:39], s68 offen offset:1024 sc1 lds
    buffer_load_dwordx4 v225, s[36:39], s68 offen offset:2048 sc1 lds
    buffer_load_dwordx4 v225, s[36:39], s68 offen offset:3072 sc1 lds
    s_add_u32 m0, s69, 65536
    s_nop 0
    buffer_load_dwordx4 v227, s[36:39], s68 offen sc1 lds
    v_lshrrev_b32 v249, 2, v224
    s_mul_i32 s70, s61, 48
    v_add_u32 v249, s70, v249
    v_and_b32 v250, 3, v224
    s_lshl_b32 s70, s98, 4
    s_add_u32 s70, s70, s99
    s_lshl_b32 s70, s70, 6
    s_add_u32 s70, s70, 1048576
    v_lshl_add_u32 v250, v250, 4, s70
    s_movk_i32 s71, 160
    v_lshl_add_u32 v251, v249, 14, v250
    v_cmp_lt_u32 s[66:67], v249, s71
    v_add_u32 v251, 0, v251
    s_nop 0
    v_cndmask_b32 v236, -1, v251, s[66:67]
    s_movk_i32 s71, 144
    v_lshl_add_u32 v251, v249, 14, v250
    v_cmp_lt_u32 s[66:67], v249, s71
    v_add_u32 v251, 262144, v251
    s_nop 0
    v_cndmask_b32 v237, -1, v251, s[66:67]
    s_movk_i32 s71, 128
    v_lshl_add_u32 v251, v249, 14, v250
    v_cmp_lt_u32 s[66:67], v249, s71
    v_add_u32 v251, 524288, v251
    s_nop 0
    v_cndmask_b32 v238, -1, v251, s[66:67]
    s_waitcnt vmcnt(19)
    s_barrier
    s_nop 0
    ds_read_b128 a[0:3], v225 offset:0
    ds_read_b128 a[4:7], v225 offset:1024
    ds_read_b128 a[8:11], v225 offset:2048
    ds_read_b128 a[12:15], v225 offset:3072
    ds_read_b128 a[16:19], v225 offset:4096
    ds_read_b128 a[20:23], v225 offset:5120
    ds_read_b128 a[24:27], v225 offset:6144
    ds_read_b128 a[28:31], v225 offset:7168
    s_waitcnt vmcnt(10)
    v_max_u32 v248, v0, v2
    v_max3_u32 v248, v4, v6, v248
    v_max3_u32 v248, v8, v10, v248
    v_max3_u32 v248, v12, v14, v248
    v_cmp_eq_u32 vcc, s92, v248
    s_nop 0
    s_cbranch_vccnz L_hre0
L_hre0_ok:
    v_swap_b32 v2, v4
    v_swap_b32 v3, v5
    v_swap_b32 v10, v12
    v_swap_b32 v11, v13
    s_nop 0
    s_add_u32 s28, s40, 262144
    buffer_load_dwordx4 v[16:19], v232, s[36:39], s28 offen sc1
    buffer_load_dwordx4 v[20:23], v233, s[36:39], s28 offen sc1
    s_add_u32 s28, s40, 393216
    buffer_load_dwordx4 v[24:27], v232, s[36:39], s28 offen sc1
    buffer_load_dwordx4 v[28:31], v233, s[36:39], s28 offen sc1
    s_add_u32 s28, s40, 524288
    buffer_load_dwordx4 v[32:35], v232, s[36:39], s28 offen sc1
    buffer_load_dwordx4 v[36:39], v233, s[36:39], s28 offen sc1
    s_add_u32 s28, s41, 0
    buffer_load_dwordx4 v[40:43], v232, s[36:39], s28 offen sc1
    buffer_load_dwordx4 v[44:47], v233, s[36:39], s28 offen sc1
    s_waitcnt lgkmcnt(4)
    v_mfma_f32_16x16x32_bf16 v[192:195], a[0:3], v[0:3], 0
    ds_read_b128 a[32:35], v225 offset:8192
    s_add_u32 s28, s41, 131072
    v_mfma_f32_16x16x32_bf16 v[196:199], a[0:3], v[4:7], 0
    ds_read_b128 a[36:39], v225 offset:9216
    buffer_load_dwordx4 v[48:51], v232, s[36:39], s28 offen sc1
    v_mfma_f32_16x16x32_bf16 v[200:203], a[4:7], v[0:3], 0
    ds_read_b128 a[40:43], v225 offset:10240
    v_mfma_f32_16x16x32_bf16 v[204:207], a[4:7], v[4:7], 0
    ds_read_b128 a[44:47], v225 offset:11264
    v_mfma_f32_16x16x32_bf16 v[208:211], a[8:11], v[0:3], 0
    s_add_u32 m0, s69, 81920
    s_add_u32 s68, s46, 0
    v_mfma_f32_16x16x32_bf16 v[212:215], a[8:11], v[4:7], 0
    buffer_load_dwordx4 v225, s[36:39], s68 offen offset:0 sc1 lds
    v_mfma_f32_16x16x32_bf16 v[216:219], a[12:15], v[0:3], 0
    v_mfma_f32_16x16x32_bf16 v[220:223], a[12:15], v[4:7], 0
    s_waitcnt lgkmcnt(4)
    v_mfma_f32_16x16x32_bf16 v[160:163], a[16:19], v[0:3], 0
    ds_read_b128 a[0:3], v225 offset:12288
    buffer_load_dwordx4 v[52:55], v233, s[36:39], s28 offen sc1
    v_mfma_f32_16x16x32_bf16 v[164:167], a[16:19], v[4:7], 0
    ds_read_b128 a[4:7], v225 offset:13312
    v_mfma_f32_16x16x32_bf16 v[168:171], a[20:23], v[0:3], 0
    ds_read_b128 a[8:11], v225 offset:14336
    v_mfma_f32_16x16x32_bf16 v[172:175], a[20:23], v[4:7], 0
    ds_read_b128 a[12:15], v225 offset:15360
    v_mfma_f32_16x16x32_bf16 v[176:179], a[24:27], v[0:3], 0
    buffer_load_dwordx4 v225, s[36:39], s68 offen offset:1024 sc1 lds
    v_mfma_f32_16x16x32_bf16 v[180:183], a[24:27], v[4:7], 0
    v_mfma_f32_16x16x32_bf16 v[184:187], a[28:31], v[0:3], 0
    v_mfma_f32_16x16x32_bf16 v[188:191], a[28:31], v[4:7], 0
    s_waitcnt lgkmcnt(4)
    v_mfma_f32_16x16x32_bf16 v[192:195], a[32:35], v[8:11], v[192:195]
    ds_read_b128 a[16:19], v225 offset:16384
    s_add_u32 s28, s41, 262144
    v_mfma_f32_16x16x32_bf16 v[196:199], a[32:35], v[12:15], v[196:199]
    ds_read_b128 a[20:23], v225 offset:17408
    buffer_load_dwordx4 v[56:59], v232, s[36:39], s28 offen sc1
    v_mfma_f32_16x16x32_bf16 v[200:203], a[36:39], v[8:11], v[200:203]
    ds_read_b128 a[24:27], v225 offset:18432
    s_waitcnt vmcnt(9)
    v_mfma_f32_16x16x32_bf16 v[204:207], a[36:39], v[12:15], v[204:207]
    ds_read_b128 a[28:31], v225 offset:19456
    v_max_u32 v248, v16, v18
    v_mfma_f32_16x16x32_bf16 v[208:211], a[40:43], v[8:11], v[208:211]
    buffer_load_dwordx4 v225, s[36:39], s68 offen offset:2048 sc1 lds
    v_max3_u32 v248, v20, v22, v248
    v_mfma_f32_16x16x32_bf16 v[212:215], a[40:43], v[12:15], v[212:215]
    v_max3_u32 v248, v24, v26, v248
    v_max3_u32 v248, v28, v30, v248
    v_mfma_f32_16x16x32_bf16 v[216:219], a[44:47], v[8:11], v[216:219]
    v_cmp_eq_u32 vcc, s92, v248
    v_mfma_f32_16x16x32_bf16 v[220:223], a[44:47], v[12:15], v[220:223]
    s_cbranch_vccnz L_hre1
L_hre1_ok:
    s_waitcnt lgkmcnt(4)
    v_mfma_f32_16x16x32_bf16 v[160:163], a[0:3], v[8:11], v[160:163]
    s_barrier
    v_mfma_f32_16x16x32_bf16 v[164:167], a[0:3], v[12:15], v[164:167]
    ds_read_b128 a[32:35], v225 offset:20480
    buffer_load_dwordx4 v[60:63], v233, s[36:39], s28 offen sc1
    v_mfma_f32_16x16x32_bf16 v[168:171], a[4:7], v[8:11], v[168:171]
    ds_read_b128 a[36:39], v225 offset:21504
    v_mfma_f32_16x16x32_bf16 v[172:175], a[4:7], v[12:15], v[172:175]
    ds_read_b128 a[40:43], v225 offset:22528
    v_mfma_f32_16x16x32_bf16 v[176:179], a[8:11], v[8:11], v[176:179]
    ds_read_b128 a[44:47], v225 offset:23552
    buffer_load_dwordx4 v225, s[36:39], s68 offen offset:3072 sc1 lds
    v_mfma_f32_16x16x32_bf16 v[180:183], a[8:11], v[12:15], v[180:183]
    v_swap_b32 v18, v20
    v_mfma_f32_16x16x32_bf16 v[184:187], a[12:15], v[8:11], v[184:187]
    v_swap_b32 v19, v21
    v_mfma_f32_16x16x32_bf16 v[188:191], a[12:15], v[12:15], v[188:191]
    v_swap_b32 v26, v28
    v_swap_b32 v27, v29
    s_waitcnt lgkmcnt(4)
    v_mfma_f32_16x16x32_bf16 v[192:195], a[16:19], v[16:19], v[192:195]
    ds_read_b128 a[0:3], v225 offset:24576
    s_add_u32 s28, s41, 393216
    v_mfma_f32_16x16x32_bf16 v[196:199], a[16:19], v[20:23], v[196:199]
    ds_read_b128 a[4:7], v225 offset:25600
    buffer_load_dwordx4 v[64:67], v232, s[36:39], s28 offen sc1
    v_mfma_f32_16x16x32_bf16 v[200:203], a[20:23], v[16:19], v[200:203]
    ds_read_b128 a[8:11], v225 offset:26624
    v_mfma_f32_16x16x32_bf16 v[204:207], a[20:23], v[20:23], v[204:207]
    ds_read_b128 a[12:15], v225 offset:27648
    v_mfma_f32_16x16x32_bf16 v[208:211], a[24:27], v[16:19], v[208:211]
    s_add_u32 m0, s69, 86016
    s_nop 0
    buffer_load_dwordx4 v227, s[36:39], s68 offen sc1 lds
    v_mfma_f32_16x16x32_bf16 v[212:215], a[24:27], v[20:23], v[212:215]
    v_mfma_f32_16x16x32_bf16 v[216:219], a[28:31], v[16:19], v[216:219]
    v_mfma_f32_16x16x32_bf16 v[220:223], a[28:31], v[20:23], v[220:223]
    s_waitcnt lgkmcnt(4)
    v_mfma_f32_16x16x32_bf16 v[160:163], a[32:35], v[16:19], v[160:163]
    ds_read_b128 a[16:19], v225 offset:28672
    buffer_load_dwordx4 v[68:71], v233, s[36:39], s28 offen sc1
    v_mfma_f32_16x16x32_bf16 v[164:167], a[32:35], v[20:23], v[164:167]
    ds_read_b128 a[20:23], v225 offset:29696
    buffer_load_dwordx4 v[240:243], v236, s[36:39], 0 offen sc1
    v_mfma_f32_16x16x32_bf16 v[168:171], a[36:39], v[16:19], v[168:171]
    ds_read_b128 a[24:27], v225 offset:30720
    v_mfma_f32_16x16x32_bf16 v[172:175], a[36:39], v[20:23], v[172:175]
    ds_read_b128 a[28:31], v225 offset:31744
    v_mfma_f32_16x16x32_bf16 v[176:179], a[40:43], v[16:19], v[176:179]
    s_add_u32 m0, s69, 102400
    s_add_u32 s68, s46, 20480
    v_mfma_f32_16x16x32_bf16 v[180:183], a[40:43], v[20:23], v[180:183]
    buffer_load_dwordx4 v225, s[36:39], s68 offen offset:0 sc1 lds
    v_mfma_f32_16x16x32_bf16 v[184:187], a[44:47], v[16:19], v[184:187]
    v_mfma_f32_16x16x32_bf16 v[188:191], a[44:47], v[20:23], v[188:191]
    s_waitcnt lgkmcnt(4)
    v_mfma_f32_16x16x32_bf16 v[192:195], a[0:3], v[24:27], v[192:195]
    ds_read_b128 a[32:35], v225 offset:32768
    s_add_u32 s28, s41, 524288
    v_mfma_f32_16x16x32_bf16 v[196:199], a[0:3], v[28:31], v[196:199]
    ds_read_b128 a[36:39], v225 offset:33792
    buffer_load_dwordx4 v[72:75], v232, s[36:39], s28 offen sc1
    v_mfma_f32_16x16x32_bf16 v[200:203], a[4:7], v[24:27], v[200:203]
    ds_read_b128 a[40:43], v225 offset:34816
    s_waitcnt vmcnt(14)
    v_mfma_f32_16x16x32_bf16 v[204:207], a[4:7], v[28:31], v[204:207]
    ds_read_b128 a[44:47], v225 offset:35840
    v_max_u32 v248, v32, v34
    v_mfma_f32_16x16x32_bf16 v[208:211], a[8:11], v[24:27], v[208:211]
    buffer_load_dwordx4 v225, s[36:39], s68 offen offset:1024 sc1 lds
    v_max3_u32 v248, v36, v38, v248
    v_mfma_f32_16x16x32_bf16 v[212:215], a[8:11], v[28:31], v[212:215]
    v_max3_u32 v248, v40, v42, v248
    v_max3_u32 v248, v44, v46, v248
    v_mfma_f32_16x16x32_bf16 v[216:219], a[12:15], v[24:27], v[216:219]
    v_cmp_eq_u32 vcc, s92, v248
    v_mfma_f32_16x16x32_bf16 v[220:223], a[12:15], v[28:31], v[220:223]
    s_cbranch_vccnz L_hre2
L_hre2_ok:
    s_waitcnt lgkmcnt(4)
    v_mfma_f32_16x16x32_bf16 v[160:163], a[16:19], v[24:27], v[160:163]
    ds_read_b128 a[0:3], v225 offset:36864
    buffer_load_dwordx4 v[76:79], v233, s[36:39], s28 offen sc1
    v_mfma_f32_16x16x32_bf16 v[164:167], a[16:19], v[28:31], v[164:167]
    ds_read_b128 a[4:7], v225 offset:37888
    v_mfma_f32_16x16x32_bf16 v[168:171], a[20:23], v[24:27], v[168:171]
    ds_read_b128 a[8:11], v225 offset:38912
    v_mfma_f32_16x16x32_bf16 v[172:175], a[20:23], v[28:31], v[172:175]
    ds_read_b128 a[12:15], v225 offset:39936
    v_mfma_f32_16x16x32_bf16 v[176:179], a[24:27], v[24:27], v[176:179]
    buffer_load_dwordx4 v225, s[36:39], s68 offen offset:2048 sc1 lds
    v_mfma_f32_16x16x32_bf16 v[180:183], a[24:27], v[28:31], v[180:183]
    v_swap_b32 v34, v36
    v_mfma_f32_16x16x32_bf16 v[184:187], a[28:31], v[24:27], v[184:187]
    v_swap_b32 v35, v37
    v_mfma_f32_16x16x32_bf16 v[188:191], a[28:31], v[28:31], v[188:191]
    v_swap_b32 v42, v44
    v_swap_b32 v43, v45
    buffer_load_dwordx4 v[244:247], v237, s[36:39], 0 offen sc1
    s_waitcnt lgkmcnt(4)
    v_mfma_f32_16x16x32_bf16 v[192:195], a[32:35], v[32:35], v[192:195]
    s_barrier
    v_mfma_f32_16x16x32_bf16 v[196:199], a[32:35], v[36:39], v[196:199]
    ds_read_b128 a[16:19], v225 offset:40960
    s_add_u32 s28, s42, 0
    v_mfma_f32_16x16x32_bf16 v[200:203], a[36:39], v[32:35], v[200:203]
    ds_read_b128 a[20:23], v225 offset:41984
    buffer_load_dwordx4 v[80:83], v232, s[36:39], s28 offen sc1
    v_mfma_f32_16x16x32_bf16 v[204:207], a[36:39], v[36:39], v[204:207]
    ds_read_b128 a[24:27], v225 offset:43008
    v_mfma_f32_16x16x32_bf16 v[208:211], a[40:43], v[32:35], v[208:211]
    ds_read_b128 a[28:31], v225 offset:44032
    buffer_load_dwordx4 v225, s[36:39], s68 offen offset:3072 sc1 lds
    v_mfma_f32_16x16x32_bf16 v[212:215], a[40:43], v[36:39], v[212:215]
    v_mfma_f32_16x16x32_bf16 v[216:219], a[44:47], v[32:35], v[216:219]
    v_mfma_f32_16x16x32_bf16 v[220:223], a[44:47], v[36:39], v[220:223]
    s_waitcnt lgkmcnt(4)
    v_mfma_f32_16x16x32_bf16 v[160:163], a[0:3], v[32:35], v[160:163]
    ds_read_b128 a[32:35], v225 offset:45056
    buffer_load_dwordx4 v[84:87], v233, s[36:39], s28 offen sc1
    v_mfma_f32_16x16x32_bf16 v[164:167], a[0:3], v[36:39], v[164:167]
    ds_read_b128 a[36:39], v225 offset:46080
    buffer_load_dwordx4 v[252:255], v238, s[36:39], 0 offen sc1
    v_mfma_f32_16x16x32_bf16 v[168:171], a[4:7], v[32:35], v[168:171]
    ds_read_b128 a[40:43], v225 offset:47104
    v_mfma_f32_16x16x32_bf16 v[172:175], a[4:7], v[36:39], v[172:175]
    ds_read_b128 a[44:47], v225 offset:48128
    v_mfma_f32_16x16x32_bf16 v[176:179], a[8:11], v[32:35], v[176:179]
    s_add_u32 m0, s69, 106496
    s_nop 0
    buffer_load_dwordx4 v227, s[36:39], s68 offen sc1 lds
    v_mfma_f32_16x16x32_bf16 v[180:183], a[8:11], v[36:39], v[180:183]
    v_mfma_f32_16x16x32_bf16 v[184:187], a[12:15], v[32:35], v[184:187]
    v_mfma_f32_16x16x32_bf16 v[188:191], a[12:15], v[36:39], v[188:191]
    s_waitcnt lgkmcnt(4)
    v_mfma_f32_16x16x32_bf16 v[192:195], a[16:19], v[40:43], v[192:195]
    ds_read_b128 a[0:3], v225 offset:49152
    s_add_u32 s28, s42, 131072
    v_mfma_f32_16x16x32_bf16 v[196:199], a[16:19], v[44:47], v[196:199]
    ds_read_b128 a[4:7], v225 offset:50176
    buffer_load_dwordx4 v[88:91], v232, s[36:39], s28 offen sc1
    v_mfma_f32_16x16x32_bf16 v[200:203], a[20:23], v[40:43], v[200:203]
    ds_read_b128 a[8:11], v225 offset:51200
    s_waitcnt vmcnt(17)
    v_mfma_f32_16x16x32_bf16 v[204:207], a[20:23], v[44:47], v[204:207]
    ds_read_b128 a[12:15], v225 offset:52224
    v_max_u32 v248, v48, v50
    v_mfma_f32_16x16x32_bf16 v[208:211], a[24:27], v[40:43], v[208:211]
    s_add_u32 m0, s69, 122880
    s_add_u32 s68, s47, 0
    v_mfma_f32_16x16x32_bf16 v[212:215], a[24:27], v[44:47], v[212:215]
    buffer_load_dwordx4 v225, s[36:39], s68 offen offset:0 sc1 lds
    v_max3_u32 v248, v52, v54, v248
    v_mfma_f32_16x16x32_bf16 v[216:219], a[28:31], v[40:43], v[216:219]
    v_max3_u32 v248, v56, v58, v248
    v_max3_u32 v248, v60, v62, v248
    v_mfma_f32_16x16x32_bf16 v[220:223], a[28:31], v[44:47], v[220:223]
    v_cmp_eq_u32 vcc, s92, v248
    s_nop 0
    s_cbranch_vccnz L_hre3
L_hre3_ok:
    s_waitcnt lgkmcnt(4)
    v_mfma_f32_16x16x32_bf16 v[160:163], a[32:35], v[40:43], v[160:163]
    ds_read_b128 a[16:19], v225 offset:53248
    buffer_load_dwordx4 v[92:95], v233, s[36:39], s28 offen sc1
    v_mfma_f32_16x16x32_bf16 v[164:167], a[32:35], v[44:47], v[164:167]
    ds_read_b128 a[20:23], v225 offset:54272
    v_mfma_f32_16x16x32_bf16 v[168:171], a[36:39], v[40:43], v[168:171]
    ds_read_b128 a[24:27], v225 offset:55296
    v_mfma_f32_16x16x32_bf16 v[172:175], a[36:39], v[44:47], v[172:175]
    ds_read_b128 a[28:31], v225 offset:56320
    v_mfma_f32_16x16x32_bf16 v[176:179], a[40:43], v[40:43], v[176:179]
    buffer_load_dwordx4 v225, s[36:39], s68 offen offset:1024 sc1 lds
    v_mfma_f32_16x16x32_bf16 v[180:183], a[40:43], v[44:47], v[180:183]
    v_swap_b32 v50, v52
    v_mfma_f32_16x16x32_bf16 v[184:187], a[44:47], v[40:43], v[184:187]
    v_swap_b32 v51, v53
    v_mfma_f32_16x16x32_bf16 v[188:191], a[44:47], v[44:47], v[188:191]
    v_swap_b32 v58, v60
    v_swap_b32 v59, v61
    s_waitcnt lgkmcnt(4)
    v_mfma_f32_16x16x32_bf16 v[192:195], a[0:3], v[48:51], v[192:195]
    ds_read_b128 a[32:35], v225 offset:57344
    s_add_u32 s28, s42, 262144
    v_mfma_f32_16x16x32_bf16 v[196:199], a[0:3], v[52:55], v[196:199]
    ds_read_b128 a[36:39], v225 offset:58368
    buffer_load_dwordx4 v[96:99], v232, s[36:39], s28 offen sc1
    v_mfma_f32_16x16x32_bf16 v[200:203], a[4:7], v[48:51], v[200:203]
    ds_read_b128 a[40:43], v225 offset:59392
    v_mfma_f32_16x16x32_bf16 v[204:207], a[4:7], v[52:55], v[204:207]
    ds_read_b128 a[44:47], v225 offset:60416
    v_mfma_f32_16x16x32_bf16 v[208:211], a[8:11], v[48:51], v[208:211]
    buffer_load_dwordx4 v225, s[36:39], s68 offen offset:2048 sc1 lds
    v_mfma_f32_16x16x32_bf16 v[212:215], a[8:11], v[52:55], v[212:215]
    v_mfma_f32_16x16x32_bf16 v[216:219], a[12:15], v[48:51], v[216:219]
    v_mfma_f32_16x16x32_bf16 v[220:223], a[12:15], v[52:55], v[220:223]
    s_waitcnt lgkmcnt(4)
    v_mfma_f32_16x16x32_bf16 v[160:163], a[16:19], v[48:51], v[160:163]
    s_barrier
    v_mfma_f32_16x16x32_bf16 v[164:167], a[16:19], v[52:55], v[164:167]
    ds_read_b128 a[0:3], v225 offset:61440
    buffer_load_dwordx4 v[100:103], v233, s[36:39], s28 offen sc1
    v_mfma_f32_16x16x32_bf16 v[168:171], a[20:23], v[48:51], v[168:171]
    ds_read_b128 a[4:7], v225 offset:62464
    v_mfma_f32_16x16x32_bf16 v[172:175], a[20:23], v[52:55], v[172:175]
    ds_read_b128 a[8:11], v225 offset:63488
    v_mfma_f32_16x16x32_bf16 v[176:179], a[24:27], v[48:51], v[176:179]
    ds_read_b128 a[12:15], v225 offset:64512
    buffer_load_dwordx4 v225, s[36:39], s68 offen offset:3072 sc1 lds
    v_mfma_f32_16x16x32_bf16 v[180:183], a[24:27], v[52:55], v[180:183]
    v_mfma_f32_16x16x32_bf16 v[184:187], a[28:31], v[48:51], v[184:187]
    v_mfma_f32_16x16x32_bf16 v[188:191], a[28:31], v[52:55], v[188:191]
    s_waitcnt lgkmcnt(4)
    v_mfma_f32_16x16x32_bf16 v[192:195], a[32:35], v[56:59], v[192:195]
    ds_read_b128 a[16:19], v234 offset:0
    s_add_u32 s28, s42, 393216
    v_mfma_f32_16x16x32_bf16 v[196:199], a[32:35], v[60:63], v[196:199]
    ds_read_b128 a[20:23], v234 offset:1024
    buffer_load_dwordx4 v[104:107], v232, s[36:39], s28 offen sc1
    v_mfma_f32_16x16x32_bf16 v[200:203], a[36:39], v[56:59], v[200:203]
    ds_read_b128 a[24:27], v234 offset:2048
    s_waitcnt vmcnt(16)
    v_mfma_f32_16x16x32_bf16 v[204:207], a[36:39], v[60:63], v[204:207]
    ds_read_b128 a[28:31], v234 offset:3072
    v_max_u32 v248, v64, v66
    v_mfma_f32_16x16x32_bf16 v[208:211], a[40:43], v[56:59], v[208:211]
    s_add_u32 m0, s69, 126976
    s_nop 0
    buffer_load_dwordx4 v227, s[36:39], s68 offen sc1 lds
    v_mfma_f32_16x16x32_bf16 v[212:215], a[40:43], v[60:63], v[212:215]
    v_max3_u32 v248, v68, v70, v248
    v_max3_u32 v248, v72, v74, v248
    v_mfma_f32_16x16x32_bf16 v[216:219], a[44:47], v[56:59], v[216:219]
    v_max3_u32 v248, v76, v78, v248
    v_cmp_eq_u32 vcc, s92, v248
    v_mfma_f32_16x16x32_bf16 v[220:223], a[44:47], v[60:63], v[220:223]
    s_cbranch_vccnz L_hre4
L_hre4_ok:
    s_waitcnt lgkmcnt(4)
    v_mfma_f32_16x16x32_bf16 v[160:163], a[0:3], v[56:59], v[160:163]
    ds_read_b128 a[32:35], v234 offset:4096
    buffer_load_dwordx4 v[108:111], v233, s[36:39], s28 offen sc1
    v_mfma_f32_16x16x32_bf16 v[164:167], a[0:3], v[60:63], v[164:167]
    ds_read_b128 a[36:39], v234 offset:5120
    v_mfma_f32_16x16x32_bf16 v[168:171], a[4:7], v[56:59], v[168:171]
    ds_read_b128 a[40:43], v234 offset:6144
    v_mfma_f32_16x16x32_bf16 v[172:175], a[4:7], v[60:63], v[172:175]
    ds_read_b128 a[44:47], v234 offset:7168
    v_mfma_f32_16x16x32_bf16 v[176:179], a[8:11], v[56:59], v[176:179]
    s_add_u32 m0, s69, 0
    s_add_u32 s68, s47, 20480
    v_mfma_f32_16x16x32_bf16 v[180:183], a[8:11], v[60:63], v[180:183]
    buffer_load_dwordx4 v225, s[36:39], s68 offen offset:0 sc1 lds
    v_mfma_f32_16x16x32_bf16 v[184:187], a[12:15], v[56:59], v[184:187]
    v_swap_b32 v66, v68
    v_mfma_f32_16x16x32_bf16 v[188:191], a[12:15], v[60:63], v[188:191]
    v_swap_b32 v67, v69
    v_swap_b32 v74, v76
    v_swap_b32 v75, v77
    s_waitcnt lgkmcnt(4)
    v_mfma_f32_16x16x32_bf16 v[192:195], a[16:19], v[64:67], v[192:195]
    ds_read_b128 a[0:3], v234 offset:8192
    s_add_u32 s28, s42, 524288
    v_mfma_f32_16x16x32_bf16 v[196:199], a[16:19], v[68:71], v[196:199]
    ds_read_b128 a[4:7], v234 offset:9216
    buffer_load_dwordx4 v[112:115], v232, s[36:39], s28 offen sc1
    v_mfma_f32_16x16x32_bf16 v[200:203], a[20:23], v[64:67], v[200:203]
    ds_read_b128 a[8:11], v234 offset:10240
    s_waitcnt vmcnt(14)
    v_mfma_f32_16x16x32_bf16 v[204:207], a[20:23], v[68:71], v[204:207]
    ds_read_b128 a[12:15], v234 offset:11264
    v_max_u32 v248, v240, v242
    v_mfma_f32_16x16x32_bf16 v[208:211], a[24:27], v[64:67], v[208:211]
    buffer_load_dwordx4 v225, s[36:39], s68 offen offset:1024 sc1 lds
    v_max3_u32 v248, v244, v246, v248
    v_mfma_f32_16x16x32_bf16 v[212:215], a[24:27], v[68:71], v[212:215]
    v_max3_u32 v248, v252, v254, v248
    v_cmp_eq_u32 vcc, s92, v248
    v_mfma_f32_16x16x32_bf16 v[216:219], a[28:31], v[64:67], v[216:219]
    s_cbranch_vccnz L_l2re
L_l2re_ok:
    v_mfma_f32_16x16x32_bf16 v[220:223], a[28:31], v[68:71], v[220:223]
    s_waitcnt lgkmcnt(4)
    v_mfma_f32_16x16x32_bf16 v[160:163], a[32:35], v[64:67], v[160:163]
    ds_read_b128 a[16:19], v234 offset:12288
    buffer_load_dwordx4 v[116:119], v233, s[36:39], s28 offen sc1
    v_mfma_f32_16x16x32_bf16 v[164:167], a[32:35], v[68:71], v[164:167]
    ds_read_b128 a[20:23], v234 offset:13312
    v_lshlrev_b32 v250, 16, v240
    v_mfma_f32_16x16x32_bf16 v[168:171], a[36:39], v[64:67], v[168:171]
    ds_read_b128 a[24:27], v234 offset:14336
    v_and_b32 v240, s93, v240
    v_mfma_f32_16x16x32_bf16 v[172:175], a[36:39], v[68:71], v[172:175]
    ds_read_b128 a[28:31], v234 offset:15360
    v_add_f32 v236, v240, v250
    v_mfma_f32_16x16x32_bf16 v[176:179], a[40:43], v[64:67], v[176:179]
    buffer_load_dwordx4 v225, s[36:39], s68 offen offset:2048 sc1 lds
    v_mul_f32 v237, v240, v240
    v_mfma_f32_16x16x32_bf16 v[180:183], a[40:43], v[68:71], v[180:183]
    v_fmac_f32 v237, v250, v250
    v_lshlrev_b32 v250, 16, v241
    v_mfma_f32_16x16x32_bf16 v[184:187], a[44:47], v[64:67], v[184:187]
    v_and_b32 v241, s93, v241
    v_add_f32 v236, v236, v241
    v_mfma_f32_16x16x32_bf16 v[188:191], a[44:47], v[68:71], v[188:191]
    v_fmac_f32 v237, v241, v241
    s_waitcnt lgkmcnt(4)
    v_mfma_f32_16x16x32_bf16 v[192:195], a[0:3], v[72:75], v[192:195]
    s_barrier
    v_mfma_f32_16x16x32_bf16 v[196:199], a[0:3], v[76:79], v[196:199]
    ds_read_b128 a[32:35], v234 offset:16384
    s_add_u32 s28, s43, 0
    v_mfma_f32_16x16x32_bf16 v[200:203], a[4:7], v[72:75], v[200:203]
    ds_read_b128 a[36:39], v234 offset:17408
    buffer_load_dwordx4 v[120:123], v232, s[36:39], s28 offen sc1
    v_mfma_f32_16x16x32_bf16 v[204:207], a[4:7], v[76:79], v[204:207]
    ds_read_b128 a[40:43], v234 offset:18432
    s_waitcnt vmcnt(14)
    v_mfma_f32_16x16x32_bf16 v[208:211], a[8:11], v[72:75], v[208:211]
    ds_read_b128 a[44:47], v234 offset:19456
    buffer_load_dwordx4 v225, s[36:39], s68 offen offset:3072 sc1 lds
    v_mfma_f32_16x16x32_bf16 v[212:215], a[8:11], v[76:79], v[212:215]
    v_max_u32 v248, v80, v82
    v_max3_u32 v248, v84, v86, v248
    v_mfma_f32_16x16x32_bf16 v[216:219], a[12:15], v[72:75], v[216:219]
    v_max3_u32 v248, v88, v90, v248
    v_max3_u32 v248, v92, v94, v248
    v_mfma_f32_16x16x32_bf16 v[220:223], a[12:15], v[76:79], v[220:223]
    v_cmp_eq_u32 vcc, s92, v248
    s_nop 0
    s_cbranch_vccnz L_hre5
L_hre5_ok:
    s_waitcnt lgkmcnt(4)
    v_mfma_f32_16x16x32_bf16 v[160:163], a[16:19], v[72:75], v[160:163]
    ds_read_b128 a[0:3], v234 offset:20480
    buffer_load_dwordx4 v[124:127], v233, s[36:39], s28 offen sc1
    v_mfma_f32_16x16x32_bf16 v[164:167], a[16:19], v[76:79], v[164:167]
    ds_read_b128 a[4:7], v234 offset:21504
    v_mfma_f32_16x16x32_bf16 v[168:171], a[20:23], v[72:75], v[168:171]
    ds_read_b128 a[8:11], v234 offset:22528
    v_mfma_f32_16x16x32_bf16 v[172:175], a[20:23], v[76:79], v[172:175]
    ds_read_b128 a[12:15], v234 offset:23552
    v_mfma_f32_16x16x32_bf16 v[176:179], a[24:27], v[72:75], v[176:179]
    s_add_u32 m0, s69, 4096
    s_nop 0
    buffer_load_dwordx4 v227, s[36:39], s68 offen sc1 lds
    v_mfma_f32_16x16x32_bf16 v[180:183], a[24:27], v[76:79], v[180:183]
    v_swap_b32 v82, v84
    v_mfma_f32_16x16x32_bf16 v[184:187], a[28:31], v[72:75], v[184:187]
    v_swap_b32 v83, v85
    v_mfma_f32_16x16x32_bf16 v[188:191], a[28:31], v[76:79], v[188:191]
    v_swap_b32 v90, v92
    v_swap_b32 v91, v93
    s_waitcnt lgkmcnt(4)
    v_mfma_f32_16x16x32_bf16 v[192:195], a[32:35], v[80:83], v[192:195]
    ds_read_b128 a[16:19], v234 offset:24576
    s_add_u32 s28, s43, 131072
    v_mfma_f32_16x16x32_bf16 v[196:199], a[32:35], v[84:87], v[196:199]
    ds_read_b128 a[20:23], v234 offset:25600
    buffer_load_dwordx4 v[128:131], v232, s[36:39], s28 offen sc1
    v_mfma_f32_16x16x32_bf16 v[200:203], a[36:39], v[80:83], v[200:203]
    ds_read_b128 a[24:27], v234 offset:26624
    v_add_f32 v236, v236, v250
    v_mfma_f32_16x16x32_bf16 v[204:207], a[36:39], v[84:87], v[204:207]
    ds_read_b128 a[28:31], v234 offset:27648
    v_fmac_f32 v237, v250, v250
    v_mfma_f32_16x16x32_bf16 v[208:211], a[40:43], v[80:83], v[208:211]
    s_add_u32 m0, s69, 20480
    s_add_u32 s68, s20, 163840
    v_mfma_f32_16x16x32_bf16 v[212:215], a[40:43], v[84:87], v[212:215]
    buffer_load_dwordx4 v225, s[36:39], s68 offen offset:0 sc1 lds
    v_lshlrev_b32 v250, 16, v242
    v_mfma_f32_16x16x32_bf16 v[216:219], a[44:47], v[80:83], v[216:219]
    v_and_b32 v242, s93, v242
    v_add_f32 v238, v242, v250
    v_mfma_f32_16x16x32_bf16 v[220:223], a[44:47], v[84:87], v[220:223]
    v_mul_f32 v239, v242, v242
    s_waitcnt lgkmcnt(4)
    v_mfma_f32_16x16x32_bf16 v[160:163], a[0:3], v[80:83], v[160:163]
    ds_read_b128 a[32:35], v234 offset:28672
    buffer_load_dwordx4 v[132:135], v233, s[36:39], s28 offen sc1
    v_mfma_f32_16x16x32_bf16 v[164:167], a[0:3], v[84:87], v[164:167]
    ds_read_b128 a[36:39], v234 offset:29696
    v_fmac_f32 v239, v250, v250
    v_mfma_f32_16x16x32_bf16 v[168:171], a[4:7], v[80:83], v[168:171]
    ds_read_b128 a[40:43], v234 offset:30720
    v_lshlrev_b32 v250, 16, v243
    v_mfma_f32_16x16x32_bf16 v[172:175], a[4:7], v[84:87], v[172:175]
    ds_read_b128 a[44:47], v234 offset:31744
    v_and_b32 v243, s93, v243
    v_mfma_f32_16x16x32_bf16 v[176:179], a[8:11], v[80:83], v[176:179]
    buffer_load_dwordx4 v225, s[36:39], s68 offen offset:1024 sc1 lds
    v_add_f32 v238, v238, v243
    v_mfma_f32_16x16x32_bf16 v[180:183], a[8:11], v[84:87], v[180:183]
    v_fmac_f32 v239, v243, v243
    v_add_f32 v238, v238, v250
    v_mfma_f32_16x16x32_bf16 v[184:187], a[12:15], v[80:83], v[184:187]
    v_fmac_f32 v239, v250, v250
    v_lshlrev_b32 v250, 16, v244
    v_mfma_f32_16x16x32_bf16 v[188:191], a[12:15], v[84:87], v[188:191]
    v_and_b32 v244, s93, v244
    s_waitcnt lgkmcnt(4)
    v_mfma_f32_16x16x32_bf16 v[192:195], a[16:19], v[88:91], v[192:195]
    ds_read_b128 a[0:3], v234 offset:32768
    s_add_u32 s28, s43, 262144
    v_mfma_f32_16x16x32_bf16 v[196:199], a[16:19], v[92:95], v[196:199]
    ds_read_b128 a[4:7], v234 offset:33792
    buffer_load_dwordx4 v[136:139], v232, s[36:39], s28 offen sc1
    v_mfma_f32_16x16x32_bf16 v[200:203], a[20:23], v[88:91], v[200:203]
    ds_read_b128 a[8:11], v234 offset:34816
    s_waitcnt vmcnt(14)
    v_mfma_f32_16x16x32_bf16 v[204:207], a[20:23], v[92:95], v[204:207]
    ds_read_b128 a[12:15], v234 offset:35840
    v_max_u32 v248, v96, v98
    v_mfma_f32_16x16x32_bf16 v[208:211], a[24:27], v[88:91], v[208:211]
    buffer_load_dwordx4 v225, s[36:39], s68 offen offset:2048 sc1 lds
    v_max3_u32 v248, v100, v102, v248
    v_mfma_f32_16x16x32_bf16 v[212:215], a[24:27], v[92:95], v[212:215]
    v_max3_u32 v248, v104, v106, v248
    v_max3_u32 v248, v108, v110, v248
    v_mfma_f32_16x16x32_bf16 v[216:219], a[28:31], v[88:91], v[216:219]
    v_cmp_eq_u32 vcc, s92, v248
    v_mfma_f32_16x16x32_bf16 v[220:223], a[28:31], v[92:95], v[220:223]
    s_cbranch_vccnz L_hre6
L_hre6_ok:
    s_waitcnt lgkmcnt(4)
    v_mfma_f32_16x16x32_bf16 v[160:163], a[32:35], v[88:91], v[160:163]
    s_barrier
    v_mfma_f32_16x16x32_bf16 v[164:167], a[32:35], v[92:95], v[164:167]
    ds_read_b128 a[16:19], v234 offset:36864
    buffer_load_dwordx4 v[140:143], v233, s[36:39], s28 offen sc1
    v_mfma_f32_16x16x32_bf16 v[168:171], a[36:39], v[88:91], v[168:171]
    ds_read_b128 a[20:23], v234 offset:37888
    v_mfma_f32_16x16x32_bf16 v[172:175], a[36:39], v[92:95], v[172:175]
    ds_read_b128 a[24:27], v234 offset:38912
    v_mfma_f32_16x16x32_bf16 v[176:179], a[40:43], v[88:91], v[176:179]
    ds_read_b128 a[28:31], v234 offset:39936
    buffer_load_dwordx4 v225, s[36:39], s68 offen offset:3072 sc1 lds
    v_mfma_f32_16x16x32_bf16 v[180:183], a[40:43], v[92:95], v[180:183]
    v_swap_b32 v98, v100
    v_mfma_f32_16x16x32_bf16 v[184:187], a[44:47], v[88:91], v[184:187]
    v_swap_b32 v99, v101
    v_mfma_f32_16x16x32_bf16 v[188:191], a[44:47], v[92:95], v[188:191]
    v_swap_b32 v106, v108
    v_swap_b32 v107, v109
    s_waitcnt lgkmcnt(4)
    v_mfma_f32_16x16x32_bf16 v[192:195], a[0:3], v[96:99], v[192:195]
    ds_read_b128 a[32:35], v234 offset:40960
    s_add_u32 s28, s43, 393216
    v_mfma_f32_16x16x32_bf16 v[196:199], a[0:3], v[100:103], v[196:199]
    ds_read_b128 a[36:39], v234 offset:41984
    buffer_load_dwordx4 v[144:147], v232, s[36:39], s28 offen sc1
    v_mfma_f32_16x16x32_bf16 v[200:203], a[4:7], v[96:99], v[200:203]
    ds_read_b128 a[40:43], v234 offset:43008
    v_add_f32 v236, v236, v244
    v_mfma_f32_16x16x32_bf16 v[204:207], a[4:7], v[100:103], v[204:207]
    ds_read_b128 a[44:47], v234 offset:44032
    v_fmac_f32 v237, v244, v244
    v_mfma_f32_16x16x32_bf16 v[208:211], a[8:11], v[96:99], v[208:211]
    s_add_u32 m0, s69, 24576
    s_nop 0
    buffer_load_dwordx4 v227, s[36:39], s68 offen sc1 lds
    v_mfma_f32_16x16x32_bf16 v[212:215], a[8:11], v[100:103], v[212:215]
    v_add_f32 v236, v236, v250
    v_fmac_f32 v237, v250, v250
    v_mfma_f32_16x16x32_bf16 v[216:219], a[12:15], v[96:99], v[216:219]
    v_lshlrev_b32 v250, 16, v245
    v_and_b32 v245, s93, v245
    v_mfma_f32_16x16x32_bf16 v[220:223], a[12:15], v[100:103], v[220:223]
    v_add_f32 v236, v236, v245
    s_waitcnt lgkmcnt(4)
    v_mfma_f32_16x16x32_bf16 v[160:163], a[16:19], v[96:99], v[160:163]
    ds_read_b128 a[0:3], v234 offset:45056
    buffer_load_dwordx4 v[148:151], v233, s[36:39], s28 offen sc1
    v_mfma_f32_16x16x32_bf16 v[164:167], a[16:19], v[100:103], v[164:167]
    ds_read_b128 a[4:7], v234 offset:46080
    v_fmac_f32 v237, v245, v245
    v_mfma_f32_16x16x32_bf16 v[168:171], a[20:23], v[96:99], v[168:171]
    ds_read_b128 a[8:11], v234 offset:47104
    v_add_f32 v236, v236, v250
    v_mfma_f32_16x16x32_bf16 v[172:175], a[20:23], v[100:103], v[172:175]
    ds_read_b128 a[12:15], v234 offset:48128
    v_fmac_f32 v237, v250, v250
    v_mfma_f32_16x16x32_bf16 v[176:179], a[24:27], v[96:99], v[176:179]
    s_add_u32 m0, s69, 40960
    s_add_u32 s68, s21, 163840
    v_mfma_f32_16x16x32_bf16 v[180:183], a[24:27], v[100:103], v[180:183]
    buffer_load_dwordx4 v225, s[36:39], s68 offen offset:0 sc1 lds
    v_lshlrev_b32 v250, 16, v246
    v_mfma_f32_16x16x32_bf16 v[184:187], a[28:31], v[96:99], v[184:187]
    v_and_b32 v246, s93, v246
    v_add_f32 v238, v238, v246
    v_mfma_f32_16x16x32_bf16 v[188:191], a[28:31], v[100:103], v[188:191]
    v_fmac_f32 v239, v246, v246
    s_waitcnt lgkmcnt(4)
    v_mfma_f32_16x16x32_bf16 v[192:195], a[32:35], v[104:107], v[192:195]
    ds_read_b128 a[16:19], v234 offset:49152
    s_add_u32 s28, s43, 524288
    v_mfma_f32_16x16x32_bf16 v[196:199], a[32:35], v[108:111], v[196:199]
    ds_read_b128 a[20:23], v234 offset:50176
    buffer_load_dwordx4 v[152:155], v232, s[36:39], s28 offen sc1
    v_mfma_f32_16x16x32_bf16 v[200:203], a[36:39], v[104:107], v[200:203]
    ds_read_b128 a[24:27], v234 offset:51200
    s_waitcnt vmcnt(14)
    v_mfma_f32_16x16x32_bf16 v[204:207], a[36:39], v[108:111], v[204:207]
    ds_read_b128 a[28:31], v234 offset:52224
    v_max_u32 v248, v112, v114
    v_mfma_f32_16x16x32_bf16 v[208:211], a[40:43], v[104:107], v[208:211]
    buffer_load_dwordx4 v225, s[36:39], s68 offen offset:1024 sc1 lds
    v_max3_u32 v248, v116, v118, v248
    v_mfma_f32_16x16x32_bf16 v[212:215], a[40:43], v[108:111], v[212:215]
    v_max3_u32 v248, v120, v122, v248
    v_max3_u32 v248, v124, v126, v248
    v_mfma_f32_16x16x32_bf16 v[216:219], a[44:47], v[104:107], v[216:219]
    v_cmp_eq_u32 vcc, s92, v248
    v_mfma_f32_16x16x32_bf16 v[220:223], a[44:47], v[108:111], v[220:223]
    s_cbranch_vccnz L_hre7
L_hre7_ok:
    s_waitcnt lgkmcnt(4)
    v_mfma_f32_16x16x32_bf16 v[160:163], a[0:3], v[104:107], v[160:163]
    ds_read_b128 a[32:35], v234 offset:53248
    buffer_load_dwordx4 v[156:159], v233, s[36:39], s28 offen sc1
    v_mfma_f32_16x16x32_bf16 v[164:167], a[0:3], v[108:111], v[164:167]
    ds_read_b128 a[36:39], v234 offset:54272
    v_mfma_f32_16x16x32_bf16 v[168:171], a[4:7], v[104:107], v[168:171]
    ds_read_b128 a[40:43], v234 offset:55296
    v_mfma_f32_16x16x32_bf16 v[172:175], a[4:7], v[108:111], v[172:175]
    ds_read_b128 a[44:47], v234 offset:56320
    v_mfma_f32_16x16x32_bf16 v[176:179], a[8:11], v[104:107], v[176:179]
    buffer_load_dwordx4 v225, s[36:39], s68 offen offset:2048 sc1 lds
    v_mfma_f32_16x16x32_bf16 v[180:183], a[8:11], v[108:111], v[180:183]
    v_swap_b32 v114, v116
    v_mfma_f32_16x16x32_bf16 v[184:187], a[12:15], v[104:107], v[184:187]
    v_swap_b32 v115, v117
    v_mfma_f32_16x16x32_bf16 v[188:191], a[12:15], v[108:111], v[188:191]
    v_swap_b32 v122, v124
    v_swap_b32 v123, v125
    s_waitcnt lgkmcnt(4)
    v_mfma_f32_16x16x32_bf16 v[192:195], a[16:19], v[112:115], v[192:195]
    s_barrier
    v_mfma_f32_16x16x32_bf16 v[196:199], a[16:19], v[116:119], v[196:199]
    ds_read_b128 a[0:3], v234 offset:57344
    v_add_f32 v238, v238, v250
    v_mfma_f32_16x16x32_bf16 v[200:203], a[20:23], v[112:115], v[200:203]
    ds_read_b128 a[4:7], v234 offset:58368
    buffer_load_dwordx4 v225, s[36:39], s68 offen offset:3072 sc1 lds
    v_mfma_f32_16x16x32_bf16 v[204:207], a[20:23], v[116:119], v[204:207]
    ds_read_b128 a[8:11], v234 offset:59392
    v_fmac_f32 v239, v250, v250
    v_mfma_f32_16x16x32_bf16 v[208:211], a[24:27], v[112:115], v[208:211]
    ds_read_b128 a[12:15], v234 offset:60416
    v_lshlrev_b32 v250, 16, v247
    v_mfma_f32_16x16x32_bf16 v[212:215], a[24:27], v[116:119], v[212:215]
    v_and_b32 v247, s93, v247
    v_add_f32 v238, v238, v247
    v_mfma_f32_16x16x32_bf16 v[216:219], a[28:31], v[112:115], v[216:219]
    s_add_u32 m0, s69, 45056
    s_nop 0
    buffer_load_dwordx4 v227, s[36:39], s68 offen sc1 lds
    v_mfma_f32_16x16x32_bf16 v[220:223], a[28:31], v[116:119], v[220:223]
    v_fmac_f32 v239, v247, v247
    s_waitcnt lgkmcnt(4)
    v_mfma_f32_16x16x32_bf16 v[160:163], a[32:35], v[112:115], v[160:163]
    ds_read_b128 a[16:19], v234 offset:61440
    v_add_f32 v238, v238, v250
    v_mfma_f32_16x16x32_bf16 v[164:167], a[32:35], v[116:119], v[164:167]
    ds_read_b128 a[20:23], v234 offset:62464
    v_fmac_f32 v239, v250, v250
    v_mfma_f32_16x16x32_bf16 v[168:171], a[36:39], v[112:115], v[168:171]
    ds_read_b128 a[24:27], v234 offset:63488
    s_add_u32 m0, s69, 61440
    v_mfma_f32_16x16x32_bf16 v[172:175], a[36:39], v[116:119], v[172:175]
    ds_read_b128 a[28:31], v234 offset:64512
    s_add_u32 s68, s22, 163840
    v_mfma_f32_16x16x32_bf16 v[176:179], a[40:43], v[112:115], v[176:179]
    buffer_load_dwordx4 v225, s[36:39], s68 offen offset:0 sc1 lds
    v_lshlrev_b32 v250, 16, v252
    v_mfma_f32_16x16x32_bf16 v[180:183], a[40:43], v[116:119], v[180:183]
    v_and_b32 v252, s93, v252
    v_add_f32 v236, v236, v252
    v_mfma_f32_16x16x32_bf16 v[184:187], a[44:47], v[112:115], v[184:187]
    buffer_load_dwordx4 v225, s[36:39], s68 offen offset:1024 sc1 lds
    v_fmac_f32 v237, v252, v252
    v_mfma_f32_16x16x32_bf16 v[188:191], a[44:47], v[116:119], v[188:191]
    v_add_f32 v236, v236, v250
    s_waitcnt lgkmcnt(4)
    v_mfma_f32_16x16x32_bf16 v[192:195], a[0:3], v[120:123], v[192:195]
    ds_read_b128 a[32:35], v235 offset:0
    s_waitcnt vmcnt(13)
    v_mfma_f32_16x16x32_bf16 v[196:199], a[0:3], v[124:127], v[196:199]
    ds_read_b128 a[36:39], v235 offset:1024
    v_max_u32 v248, v128, v130
    v_mfma_f32_16x16x32_bf16 v[200:203], a[4:7], v[120:123], v[200:203]
    ds_read_b128 a[40:43], v235 offset:2048
    buffer_load_dwordx4 v225, s[36:39], s68 offen offset:2048 sc1 lds
    v_mfma_f32_16x16x32_bf16 v[204:207], a[4:7], v[124:127], v[204:207]
    ds_read_b128 a[44:47], v235 offset:3072
    v_max3_u32 v248, v132, v134, v248
    v_mfma_f32_16x16x32_bf16 v[208:211], a[8:11], v[120:123], v[208:211]
    v_max3_u32 v248, v136, v138, v248
    v_max3_u32 v248, v140, v142, v248
    v_mfma_f32_16x16x32_bf16 v[212:215], a[8:11], v[124:127], v[212:215]
    v_cmp_eq_u32 vcc, s92, v248
    v_mfma_f32_16x16x32_bf16 v[216:219], a[12:15], v[120:123], v[216:219]
    buffer_load_dwordx4 v225, s[36:39], s68 offen offset:3072 sc1 lds
    v_mfma_f32_16x16x32_bf16 v[220:223], a[12:15], v[124:127], v[220:223]
    s_cbranch_vccnz L_hre8
L_hre8_ok:
    s_waitcnt lgkmcnt(4)
    v_mfma_f32_16x16x32_bf16 v[160:163], a[16:19], v[120:123], v[160:163]
    ds_read_b128 a[0:3], v235 offset:4096
    v_mfma_f32_16x16x32_bf16 v[164:167], a[16:19], v[124:127], v[164:167]
    ds_read_b128 a[4:7], v235 offset:5120
    v_mfma_f32_16x16x32_bf16 v[168:171], a[20:23], v[120:123], v[168:171]
    ds_read_b128 a[8:11], v235 offset:6144
    s_add_u32 m0, s69, 65536
    v_mfma_f32_16x16x32_bf16 v[172:175], a[20:23], v[124:127], v[172:175]
    ds_read_b128 a[12:15], v235 offset:7168
    buffer_load_dwordx4 v227, s[36:39], s68 offen sc1 lds
    v_mfma_f32_16x16x32_bf16 v[176:179], a[24:27], v[120:123], v[176:179]
    v_swap_b32 v130, v132
    v_mfma_f32_16x16x32_bf16 v[180:183], a[24:27], v[124:127], v[180:183]
    v_swap_b32 v131, v133
    v_mfma_f32_16x16x32_bf16 v[184:187], a[28:31], v[120:123], v[184:187]
    s_add_u32 m0, s69, 81920
    s_add_u32 s68, s23, 163840
    v_mfma_f32_16x16x32_bf16 v[188:191], a[28:31], v[124:127], v[188:191]
    buffer_load_dwordx4 v225, s[36:39], s68 offen offset:0 sc1 lds
    v_swap_b32 v138, v140
    v_swap_b32 v139, v141
    s_waitcnt lgkmcnt(4)
    v_mfma_f32_16x16x32_bf16 v[192:195], a[32:35], v[128:131], v[192:195]
    ds_read_b128 a[16:19], v235 offset:8192
    v_fmac_f32 v237, v250, v250
    v_mfma_f32_16x16x32_bf16 v[196:199], a[32:35], v[132:135], v[196:199]
    ds_read_b128 a[20:23], v235 offset:9216
    v_lshlrev_b32 v250, 16, v253
    v_mfma_f32_16x16x32_bf16 v[200:203], a[36:39], v[128:131], v[200:203]
    ds_read_b128 a[24:27], v235 offset:10240
    buffer_load_dwordx4 v225, s[36:39], s68 offen offset:1024 sc1 lds
    v_mfma_f32_16x16x32_bf16 v[204:207], a[36:39], v[132:135], v[204:207]
    ds_read_b128 a[28:31], v235 offset:11264
    v_and_b32 v253, s93, v253
    v_mfma_f32_16x16x32_bf16 v[208:211], a[40:43], v[128:131], v[208:211]
    v_add_f32 v236, v236, v253
    v_fmac_f32 v237, v253, v253
    v_mfma_f32_16x16x32_bf16 v[212:215], a[40:43], v[132:135], v[212:215]
    v_add_f32 v236, v236, v250
    v_fmac_f32 v237, v250, v250
    v_mfma_f32_16x16x32_bf16 v[216:219], a[44:47], v[128:131], v[216:219]
    buffer_load_dwordx4 v225, s[36:39], s68 offen offset:2048 sc1 lds
    v_lshlrev_b32 v250, 16, v254
    v_mfma_f32_16x16x32_bf16 v[220:223], a[44:47], v[132:135], v[220:223]
    v_and_b32 v254, s93, v254
    s_waitcnt lgkmcnt(4)
    v_mfma_f32_16x16x32_bf16 v[160:163], a[0:3], v[128:131], v[160:163]
    s_barrier
    v_mfma_f32_16x16x32_bf16 v[164:167], a[0:3], v[132:135], v[164:167]
    ds_read_b128 a[32:35], v225 offset:0
    v_add_f32 v238, v238, v254
    v_mfma_f32_16x16x32_bf16 v[168:171], a[4:7], v[128:131], v[168:171]
    ds_read_b128 a[36:39], v225 offset:1024
    buffer_load_dwordx4 v225, s[36:39], s68 offen offset:3072 sc1 lds
    v_mfma_f32_16x16x32_bf16 v[172:175], a[4:7], v[132:135], v[172:175]
    ds_read_b128 a[40:43], v225 offset:2048
    v_fmac_f32 v239, v254, v254
    v_mfma_f32_16x16x32_bf16 v[176:179], a[8:11], v[128:131], v[176:179]
    ds_read_b128 a[44:47], v225 offset:3072
    v_add_f32 v238, v238, v250
    v_mfma_f32_16x16x32_bf16 v[180:183], a[8:11], v[132:135], v[180:183]
    v_fmac_f32 v239, v250, v250
    v_lshlrev_b32 v250, 16, v255
    v_mfma_f32_16x16x32_bf16 v[184:187], a[12:15], v[128:131], v[184:187]
    s_add_u32 m0, s69, 86016
    s_nop 0
    buffer_load_dwordx4 v227, s[36:39], s68 offen sc1 lds
    v_mfma_f32_16x16x32_bf16 v[188:191], a[12:15], v[132:135], v[188:191]
    v_and_b32 v255, s93, v255
    s_waitcnt lgkmcnt(4)
    v_mfma_f32_16x16x32_bf16 v[192:195], a[16:19], v[136:139], v[192:195]
    ds_read_b128 a[0:3], v225 offset:4096
    s_waitcnt vmcnt(13)
    v_mfma_f32_16x16x32_bf16 v[196:199], a[16:19], v[140:143], v[196:199]
    ds_read_b128 a[4:7], v225 offset:5120
    v_max_u32 v248, v144, v146
    v_mfma_f32_16x16x32_bf16 v[200:203], a[20:23], v[136:139], v[200:203]
    ds_read_b128 a[8:11], v225 offset:6144
    buffer_load_dwordx4 a[140:143], v225, s[36:39], s30 offen offset:3072 sc1
    v_mfma_f32_16x16x32_bf16 v[204:207], a[20:23], v[140:143], v[204:207]
    ds_read_b128 a[12:15], v225 offset:7168
    v_max3_u32 v248, v148, v150, v248
    v_mfma_f32_16x16x32_bf16 v[208:211], a[24:27], v[136:139], v[208:211]
    v_max3_u32 v248, v152, v154, v248
    v_max3_u32 v248, v156, v158, v248
    v_mfma_f32_16x16x32_bf16 v[212:215], a[24:27], v[140:143], v[212:215]
    v_cmp_eq_u32 vcc, s92, v248
    v_mfma_f32_16x16x32_bf16 v[216:219], a[28:31], v[136:139], v[216:219]
    buffer_load_dwordx4 a[144:147], v227, s[36:39], s30 offen sc1
    v_mfma_f32_16x16x32_bf16 v[220:223], a[28:31], v[140:143], v[220:223]
    s_cbranch_vccnz L_hre9
L_hre9_ok:
    s_waitcnt lgkmcnt(4)
    v_mfma_f32_16x16x32_bf16 v[160:163], a[32:35], v[136:139], v[160:163]
    ds_read_b128 a[16:19], v225 offset:8192
    v_mfma_f32_16x16x32_bf16 v[164:167], a[32:35], v[140:143], v[164:167]
    ds_read_b128 a[20:23], v225 offset:9216
    v_mfma_f32_16x16x32_bf16 v[168:171], a[36:39], v[136:139], v[168:171]
    ds_read_b128 a[24:27], v225 offset:10240
    s_add_u32 s30, s49, 81920
    v_mfma_f32_16x16x32_bf16 v[172:175], a[36:39], v[140:143], v[172:175]
    ds_read_b128 a[28:31], v225 offset:11264
    buffer_load_dwordx4 a[148:151], v225, s[36:39], s30 offen offset:0 sc1
    v_mfma_f32_16x16x32_bf16 v[176:179], a[40:43], v[136:139], v[176:179]
    v_swap_b32 v146, v148
    v_mfma_f32_16x16x32_bf16 v[180:183], a[40:43], v[140:143], v[180:183]
    v_swap_b32 v147, v149
    v_mfma_f32_16x16x32_bf16 v[184:187], a[44:47], v[136:139], v[184:187]
    buffer_load_dwordx4 a[152:155], v225, s[36:39], s30 offen offset:1024 sc1
    v_mfma_f32_16x16x32_bf16 v[188:191], a[44:47], v[140:143], v[188:191]
    v_swap_b32 v154, v156
    v_swap_b32 v155, v157
    s_waitcnt lgkmcnt(4)
    v_mfma_f32_16x16x32_bf16 v[192:195], a[0:3], v[144:147], v[192:195]
    ds_read_b128 a[32:35], v225 offset:12288
    v_add_f32 v238, v238, v255
    v_mfma_f32_16x16x32_bf16 v[196:199], a[0:3], v[148:151], v[196:199]
    ds_read_b128 a[36:39], v225 offset:13312
    v_fmac_f32 v239, v255, v255
    v_mfma_f32_16x16x32_bf16 v[200:203], a[4:7], v[144:147], v[200:203]
    ds_read_b128 a[40:43], v225 offset:14336
    buffer_load_dwordx4 a[156:159], v225, s[36:39], s30 offen offset:2048 sc1
    v_mfma_f32_16x16x32_bf16 v[204:207], a[4:7], v[148:151], v[204:207]
    ds_read_b128 a[44:47], v225 offset:15360
    v_add_f32 v238, v238, v250
    v_mfma_f32_16x16x32_bf16 v[208:211], a[8:11], v[144:147], v[208:211]
    v_fmac_f32 v239, v250, v250
    v_add_f32_dpp v236, v236, v236 row_shr:4 row_mask:0xf bank_mask:0xf bound_ctrl:1
    v_mfma_f32_16x16x32_bf16 v[212:215], a[8:11], v[148:151], v[212:215]
    v_add_f32_dpp v237, v237, v237 row_shr:4 row_mask:0xf bank_mask:0xf bound_ctrl:1
    v_add_f32_dpp v238, v238, v238 row_shr:4 row_mask:0xf bank_mask:0xf bound_ctrl:1
    v_mfma_f32_16x16x32_bf16 v[216:219], a[12:15], v[144:147], v[216:219]
    buffer_load_dwordx4 a[160:163], v225, s[36:39], s30 offen offset:3072 sc1
    v_add_f32_dpp v239, v239, v239 row_shr:4 row_mask:0xf bank_mask:0xf bound_ctrl:1
    v_mfma_f32_16x16x32_bf16 v[220:223], a[12:15], v[148:151], v[220:223]
    v_add_f32_dpp v236, v236, v236 row_shr:8 row_mask:0xf bank_mask:0xf bound_ctrl:1
    s_waitcnt lgkmcnt(4)
    v_mfma_f32_16x16x32_bf16 v[160:163], a[16:19], v[144:147], v[160:163]
    ds_read_b128 a[0:3], v225 offset:16384
    v_add_f32_dpp v237, v237, v237 row_shr:8 row_mask:0xf bank_mask:0xf bound_ctrl:1
    v_mfma_f32_16x16x32_bf16 v[164:167], a[16:19], v[148:151], v[164:167]
    ds_read_b128 a[4:7], v225 offset:17408
    v_add_f32_dpp v238, v238, v238 row_shr:8 row_mask:0xf bank_mask:0xf bound_ctrl:1
    v_mfma_f32_16x16x32_bf16 v[168:171], a[20:23], v[144:147], v[168:171]
    ds_read_b128 a[8:11], v225 offset:18432
    buffer_load_dwordx4 a[164:167], v227, s[36:39], s30 offen sc1
    v_mfma_f32_16x16x32_bf16 v[172:175], a[20:23], v[148:151], v[172:175]
    ds_read_b128 a[12:15], v225 offset:19456
    v_add_f32_dpp v239, v239, v239 row_shr:8 row_mask:0xf bank_mask:0xf bound_ctrl:1
    v_mfma_f32_16x16x32_bf16 v[176:179], a[24:27], v[144:147], v[176:179]
    v_and_b32 v249, 3, v224
    v_lshlrev_b32 v249, 8, v249
    v_mfma_f32_16x16x32_bf16 v[180:183], a[24:27], v[148:151], v[180:183]
    v_lshrrev_b32 v250, 4, v224
    s_lshl_b32 s70, s61, 2
    v_mfma_f32_16x16x32_bf16 v[184:187], a[28:31], v[144:147], v[184:187]
    s_add_u32 s30, s50, 81920
    buffer_load_dwordx4 a[168:171], v225, s[36:39], s30 offen offset:0 sc1
    v_mfma_f32_16x16x32_bf16 v[188:191], a[28:31], v[148:151], v[188:191]
    v_add_u32 v250, s70, v250
    s_waitcnt lgkmcnt(4)
    v_mfma_f32_16x16x32_bf16 v[192:195], a[32:35], v[152:155], v[192:195]
    s_barrier
    v_mfma_f32_16x16x32_bf16 v[196:199], a[32:35], v[156:159], v[196:199]
    ds_read_b128 a[16:19], v225 offset:20480
    v_lshl_add_u32 v249, v250, 3, v249
    v_mfma_f32_16x16x32_bf16 v[200:203], a[36:39], v[152:155], v[200:203]
    ds_read_b128 a[20:23], v225 offset:21504
    buffer_load_dwordx4 a[172:175], v225, s[36:39], s30 offen offset:1024 sc1
    v_mfma_f32_16x16x32_bf16 v[204:207], a[36:39], v[156:159], v[204:207]
    ds_read_b128 a[24:27], v225 offset:22528
    v_add_u32 v249, 143360, v249
    v_mfma_f32_16x16x32_bf16 v[208:211], a[40:43], v[152:155], v[208:211]
    ds_read_b128 a[28:31], v225 offset:23552
    v_and_b32 v250, 12, v224
    v_mfma_f32_16x16x32_bf16 v[212:215], a[40:43], v[156:159], v[212:215]
    v_cmp_eq_u32 s[66:67], 12, v250
    v_mov_b32 v250, 145408
    v_mfma_f32_16x16x32_bf16 v[216:219], a[44:47], v[152:155], v[216:219]
    buffer_load_dwordx4 a[176:179], v225, s[36:39], s30 offen offset:2048 sc1
    s_nop 0
    v_mfma_f32_16x16x32_bf16 v[220:223], a[44:47], v[156:159], v[220:223]
    v_cndmask_b32 v249, v250, v249, s[66:67]
    s_waitcnt lgkmcnt(4)
    v_mfma_f32_16x16x32_bf16 v[160:163], a[0:3], v[152:155], v[160:163]
    ds_read_b128 a[32:35], v225 offset:24576
    v_mfma_f32_16x16x32_bf16 v[164:167], a[0:3], v[156:159], v[164:167]
    ds_read_b128 a[36:39], v225 offset:25600
    v_mfma_f32_16x16x32_bf16 v[168:171], a[4:7], v[152:155], v[168:171]
    ds_read_b128 a[40:43], v225 offset:26624
    buffer_load_dwordx4 a[180:183], v225, s[36:39], s30 offen offset:3072 sc1
    v_mfma_f32_16x16x32_bf16 v[172:175], a[4:7], v[156:159], v[172:175]
    ds_read_b128 a[44:47], v225 offset:27648
    v_mul_f32 v192, v192, v208
    v_mfma_f32_16x16x32_bf16 v[176:179], a[8:11], v[152:155], v[176:179]
    v_mul_f32 v193, v193, v209
    v_mul_f32 v194, v194, v210
    v_mfma_f32_16x16x32_bf16 v[180:183], a[8:11], v[156:159], v[180:183]
    v_mul_f32 v195, v195, v211
    v_cvt_pk_bf16_f32 v240, v192, v193
    v_mfma_f32_16x16x32_bf16 v[184:187], a[12:15], v[152:155], v[184:187]
    buffer_load_dwordx4 a[184:187], v227, s[36:39], s30 offen sc1
    v_cvt_pk_bf16_f32 v241, v194, v195
    v_mfma_f32_16x16x32_bf16 v[188:191], a[12:15], v[156:159], v[188:191]
    v_mul_f32 v200, v200, v216
    v_mul_f32 v201, v201, v217
    v_mul_f32 v202, v202, v218
    v_mul_f32 v203, v203, v219
    v_cvt_pk_bf16_f32 v242, v200, v201
    v_cvt_pk_bf16_f32 v243, v202, v203
    v_mul_f32 v196, v196, v212
    v_mul_f32 v197, v197, v213
    v_mul_f32 v198, v198, v214
    v_mul_f32 v199, v199, v215
    v_cvt_pk_bf16_f32 v244, v196, v197
    v_cvt_pk_bf16_f32 v245, v198, v199
    v_mul_f32 v204, v204, v220
    v_mul_f32 v205, v205, v221
    v_mul_f32 v206, v206, v222
    v_mul_f32 v207, v207, v223
    v_cvt_pk_bf16_f32 v246, v204, v205
    v_cvt_pk_bf16_f32 v247, v206, v207
    s_waitcnt lgkmcnt(4)
    v_mfma_f32_16x16x32_bf16 v[192:195], a[16:19], v[0:3], 0
    ds_read_b128 a[0:3], v225 offset:28672
    buffer_load_dword v255, v226, s[36:39], 0 offen sc1
    v_mfma_f32_16x16x32_bf16 v[196:199], a[16:19], v[4:7], 0
    ds_read_b128 a[4:7], v225 offset:29696
    buffer_store_dwordx4 v[240:243], v225, s[36:39], s3 offen sc1
    v_mfma_f32_16x16x32_bf16 v[200:203], a[20:23], v[0:3], 0
    ds_read_b128 a[8:11], v225 offset:30720
    s_add_u32 s30, s51, 81920
    v_mfma_f32_16x16x32_bf16 v[204:207], a[20:23], v[4:7], 0
    ds_read_b128 a[12:15], v225 offset:31744
    buffer_load_dwordx4 a[188:191], v225, s[36:39], s30 offen offset:0 sc1
    v_mfma_f32_16x16x32_bf16 v[208:211], a[24:27], v[0:3], 0
    buffer_store_dwordx4 v[244:247], v225, s[36:39], s31 offen sc1
    s_add_u32 s3, s3, 16384
    v_mfma_f32_16x16x32_bf16 v[212:215], a[24:27], v[4:7], 0
    s_add_u32 s31, s31, 16384
    ds_write_b64 v249, v[236:237]
    v_mfma_f32_16x16x32_bf16 v[216:219], a[28:31], v[0:3], 0
    buffer_load_dwordx4 a[192:195], v225, s[36:39], s30 offen offset:1024 sc1
    ds_write_b64 v249, v[238:239] offset:128
    v_mfma_f32_16x16x32_bf16 v[220:223], a[28:31], v[4:7], 0
    s_waitcnt lgkmcnt(6)
    v_mfma_f32_16x16x32_bf16 v[192:195], a[32:35], v[8:11], v[192:195]
    ds_read_b128 a[16:19], v225 offset:32768
    v_mul_f32 v160, v160, v176
    v_mfma_f32_16x16x32_bf16 v[196:199], a[32:35], v[12:15], v[196:199]
    ds_read_b128 a[20:23], v225 offset:33792
    v_mul_f32 v161, v161, v177
    v_mfma_f32_16x16x32_bf16 v[200:203], a[36:39], v[8:11], v[200:203]
    ds_read_b128 a[24:27], v225 offset:34816
    buffer_load_dwordx4 a[196:199], v225, s[36:39], s30 offen offset:2048 sc1
    v_mfma_f32_16x16x32_bf16 v[204:207], a[36:39], v[12:15], v[204:207]
    ds_read_b128 a[28:31], v225 offset:35840
    v_mul_f32 v162, v162, v178
    v_mfma_f32_16x16x32_bf16 v[208:211], a[40:43], v[8:11], v[208:211]
    v_mul_f32 v163, v163, v179
    v_cvt_pk_bf16_f32 v240, v160, v161
    v_mfma_f32_16x16x32_bf16 v[212:215], a[40:43], v[12:15], v[212:215]
    v_cvt_pk_bf16_f32 v241, v162, v163
    v_mul_f32 v168, v168, v184
    v_mfma_f32_16x16x32_bf16 v[216:219], a[44:47], v[8:11], v[216:219]
    buffer_load_dwordx4 a[200:203], v225, s[36:39], s30 offen offset:3072 sc1
    v_mul_f32 v169, v169, v185
    v_mfma_f32_16x16x32_bf16 v[220:223], a[44:47], v[12:15], v[220:223]
    v_mul_f32 v170, v170, v186
    s_waitcnt lgkmcnt(6)
    v_mfma_f32_16x16x32_bf16 v[192:195], a[0:3], v[16:19], v[192:195]
    ds_read_b128 a[32:35], v225 offset:36864
    v_mul_f32 v171, v171, v187
    v_mfma_f32_16x16x32_bf16 v[196:199], a[0:3], v[20:23], v[196:199]
    ds_read_b128 a[36:39], v225 offset:37888
    v_cvt_pk_bf16_f32 v242, v168, v169
    v_mfma_f32_16x16x32_bf16 v[200:203], a[4:7], v[16:19], v[200:203]
    ds_read_b128 a[40:43], v225 offset:38912
    buffer_load_dwordx4 a[204:207], v227, s[36:39], s30 offen sc1
    v_mfma_f32_16x16x32_bf16 v[204:207], a[4:7], v[20:23], v[204:207]
    ds_read_b128 a[44:47], v225 offset:39936
    v_cvt_pk_bf16_f32 v243, v170, v171
    v_mfma_f32_16x16x32_bf16 v[208:211], a[8:11], v[16:19], v[208:211]
    buffer_store_dwordx4 v[240:243], v225, s[36:39], s3 offen sc1
    v_mul_f32 v164, v164, v180
    v_mfma_f32_16x16x32_bf16 v[212:215], a[8:11], v[20:23], v[212:215]
    v_mul_f32 v165, v165, v181
    v_mul_f32 v166, v166, v182
    v_mfma_f32_16x16x32_bf16 v[216:219], a[12:15], v[16:19], v[216:219]
    s_add_u32 s30, s48, 163840
    buffer_load_dwordx4 a[208:211], v225, s[36:39], s30 offen offset:0 sc1
    v_mfma_f32_16x16x32_bf16 v[220:223], a[12:15], v[20:23], v[220:223]
    v_mul_f32 v167, v167, v183
    s_waitcnt lgkmcnt(4)
    v_mfma_f32_16x16x32_bf16 v[192:195], a[16:19], v[24:27], v[192:195]
    s_waitcnt vmcnt(32)
    s_barrier
    v_mfma_f32_16x16x32_bf16 v[196:199], a[16:19], v[28:31], v[196:199]
    ds_read_b128 a[0:3], v225 offset:40960
    v_cvt_pk_bf16_f32 v244, v164, v165
    v_mfma_f32_16x16x32_bf16 v[200:203], a[20:23], v[24:27], v[200:203]
    ds_read_b128 a[4:7], v225 offset:41984
    buffer_load_dwordx4 a[212:215], v225, s[36:39], s30 offen offset:1024 sc1
    v_mfma_f32_16x16x32_bf16 v[204:207], a[20:23], v[28:31], v[204:207]
    ds_read_b128 a[8:11], v225 offset:43008
    v_cvt_pk_bf16_f32 v245, v166, v167
    v_mfma_f32_16x16x32_bf16 v[208:211], a[24:27], v[24:27], v[208:211]
    ds_read_b128 a[12:15], v225 offset:44032
    v_mul_f32 v172, v172, v188
    v_mfma_f32_16x16x32_bf16 v[212:215], a[24:27], v[28:31], v[212:215]
    v_mul_f32 v173, v173, v189
    v_mul_f32 v174, v174, v190
    v_mfma_f32_16x16x32_bf16 v[216:219], a[28:31], v[24:27], v[216:219]
    buffer_load_dwordx4 a[216:219], v225, s[36:39], s30 offen offset:2048 sc1
    v_mul_f32 v175, v175, v191
    v_mfma_f32_16x16x32_bf16 v[220:223], a[28:31], v[28:31], v[220:223]
    v_cvt_pk_bf16_f32 v246, v172, v173
    s_waitcnt lgkmcnt(4)
    v_mfma_f32_16x16x32_bf16 v[192:195], a[32:35], v[32:35], v[192:195]
    ds_read_b128 a[16:19], v225 offset:45056
    v_cvt_pk_bf16_f32 v247, v174, v175
    v_mfma_f32_16x16x32_bf16 v[196:199], a[32:35], v[36:39], v[196:199]
    ds_read_b128 a[20:23], v225 offset:46080
    buffer_store_dwordx4 v[244:247], v225, s[36:39], s31 offen sc1
    v_mfma_f32_16x16x32_bf16 v[200:203], a[36:39], v[32:35], v[200:203]
    ds_read_b128 a[24:27], v225 offset:47104
    buffer_load_dwordx4 a[220:223], v225, s[36:39], s30 offen offset:3072 sc1
    v_mfma_f32_16x16x32_bf16 v[204:207], a[36:39], v[36:39], v[204:207]
    ds_read_b128 a[28:31], v225 offset:48128
    s_add_u32 s3, s3, 16384
    v_mfma_f32_16x16x32_bf16 v[208:211], a[40:43], v[32:35], v[208:211]
    s_add_u32 s31, s31, 16384
    v_and_b32 v249, 31, v224
    v_mfma_f32_16x16x32_bf16 v[212:215], a[40:43], v[36:39], v[212:215]
    v_lshlrev_b32 v249, 3, v249
    s_lshl_b32 s70, s61, 8
    v_mfma_f32_16x16x32_bf16 v[216:219], a[44:47], v[32:35], v[216:219]
    buffer_load_dwordx4 a[224:227], v227, s[36:39], s30 offen sc1
    s_add_u32 s70, s70, 143360
    v_mfma_f32_16x16x32_bf16 v[220:223], a[44:47], v[36:39], v[220:223]
    v_add_u32 v249, s70, v249
    s_waitcnt lgkmcnt(4)
    v_mfma_f32_16x16x32_bf16 v[192:195], a[0:3], v[40:43], v[192:195]
    ds_read_b128 a[32:35], v225 offset:49152
    ds_read_b64 v[236:237], v249
    v_mfma_f32_16x16x32_bf16 v[196:199], a[0:3], v[44:47], v[196:199]
    ds_read_b128 a[36:39], v225 offset:50176
    s_lshl_b32 s70, s98, 4
    v_mfma_f32_16x16x32_bf16 v[200:203], a[4:7], v[40:43], v[200:203]
    ds_read_b128 a[40:43], v225 offset:51200
    s_add_u32 s30, s49, 163840
    v_mfma_f32_16x16x32_bf16 v[204:207], a[4:7], v[44:47], v[204:207]
    ds_read_b128 a[44:47], v225 offset:52224
    buffer_load_dwordx4 a[228:231], v225, s[36:39], s30 offen offset:0 sc1
    v_mfma_f32_16x16x32_bf16 v[208:211], a[8:11], v[40:43], v[208:211]
    s_add_u32 s70, s70, s99
    s_lshl_b32 s70, s70, 2
    v_mfma_f32_16x16x32_bf16 v[212:215], a[8:11], v[44:47], v[212:215]
    s_add_u32 s70, s70, s61
    s_and_b32 s71, s70, 15
    v_mfma_f32_16x16x32_bf16 v[216:219], a[12:15], v[40:43], v[216:219]
    buffer_load_dwordx4 a[232:235], v225, s[36:39], s30 offen offset:1024 sc1
    s_andn2_b32 s70, s70, 15
    v_mfma_f32_16x16x32_bf16 v[220:223], a[12:15], v[44:47], v[220:223]
    s_lshl_b32 s70, s70, 1
    s_waitcnt lgkmcnt(5)
    v_mfma_f32_16x16x32_bf16 v[192:195], a[16:19], v[48:51], v[192:195]
    ds_read_b128 a[0:3], v225 offset:53248
    s_waitcnt vmcnt(16)
    v_mfma_f32_16x16x32_bf16 v[196:199], a[16:19], v[52:55], v[196:199]
    ds_read_b128 a[4:7], v225 offset:54272
    v_cmp_ne_u32 vcc, s60, v255
    v_mfma_f32_16x16x32_bf16 v[200:203], a[20:23], v[48:51], v[200:203]
    ds_read_b128 a[8:11], v225 offset:55296
    buffer_load_dwordx4 a[236:239], v225, s[36:39], s30 offen offset:2048 sc1
    v_mfma_f32_16x16x32_bf16 v[204:207], a[20:23], v[52:55], v[204:207]
    ds_read_b128 a[12:15], v225 offset:56320
    v_mfma_f32_16x16x32_bf16 v[208:211], a[24:27], v[48:51], v[208:211]
    s_cbranch_vccnz L_fp
L_fp_ok:
    v_mfma_f32_16x16x32_bf16 v[212:215], a[24:27], v[52:55], v[212:215]
    s_add_u32 s70, s70, s71
    s_lshl_b32 s70, s70, 3
    v_mfma_f32_16x16x32_bf16 v[216:219], a[28:31], v[48:51], v[216:219]
    buffer_load_dwordx4 a[240:243], v225, s[36:39], s30 offen offset:3072 sc1
    s_add_u32 s70, s70, 163840
    v_mfma_f32_16x16x32_bf16 v[220:223], a[28:31], v[52:55], v[220:223]
    v_and_b32 v250, 16, v224
    s_waitcnt lgkmcnt(4)
    v_mfma_f32_16x16x32_bf16 v[192:195], a[32:35], v[56:59], v[192:195]
    ds_read_b128 a[16:19], v225 offset:57344
    v_lshl_add_u32 v250, v250, 3, s70
    v_mfma_f32_16x16x32_bf16 v[196:199], a[32:35], v[60:63], v[196:199]
    ds_read_b128 a[20:23], v225 offset:58368
    v_and_b32 v251, 47, v224
    v_mfma_f32_16x16x32_bf16 v[200:203], a[36:39], v[56:59], v[200:203]
    ds_read_b128 a[24:27], v225 offset:59392
    v_cmp_eq_u32 s[66:67], 15, v251
    v_mfma_f32_16x16x32_bf16 v[204:207], a[36:39], v[60:63], v[204:207]
    ds_read_b128 a[28:31], v225 offset:60416
    v_mov_b32 v239, s60
    v_mfma_f32_16x16x32_bf16 v[208:211], a[40:43], v[56:59], v[208:211]
    buffer_load_dwordx4 a[244:247], v227, s[36:39], s30 offen sc1
    s_nop 0
    v_mfma_f32_16x16x32_bf16 v[212:215], a[40:43], v[60:63], v[212:215]
    v_cndmask_b32 v250, -1, v250, s[66:67]
    v_mfma_f32_16x16x32_bf16 v[216:219], a[44:47], v[56:59], v[216:219]
    v_add_f32_dpp v236, v236, v236 row_shr:1 row_mask:0xf bank_mask:0xf bound_ctrl:1
    v_add_f32_dpp v237, v237, v237 row_shr:1 row_mask:0xf bank_mask:0xf bound_ctrl:1
    v_mfma_f32_16x16x32_bf16 v[220:223], a[44:47], v[60:63], v[220:223]
    s_nop 0
    s_waitcnt lgkmcnt(4)
    v_mfma_f32_16x16x32_bf16 v[192:195], a[0:3], v[64:67], v[192:195]
    s_barrier
    v_mfma_f32_16x16x32_bf16 v[196:199], a[0:3], v[68:71], v[196:199]
    ds_read_b128 a[32:35], v225 offset:61440
    v_add_f32_dpp v236, v236, v236 row_shr:2 row_mask:0xf bank_mask:0xf bound_ctrl:1
    v_mfma_f32_16x16x32_bf16 v[200:203], a[4:7], v[64:67], v[200:203]
    ds_read_b128 a[36:39], v225 offset:62464
    v_add_f32_dpp v237, v237, v237 row_shr:2 row_mask:0xf bank_mask:0xf bound_ctrl:1
    v_mfma_f32_16x16x32_bf16 v[204:207], a[4:7], v[68:71], v[204:207]
    ds_read_b128 a[40:43], v225 offset:63488
    s_nop 0
    v_mfma_f32_16x16x32_bf16 v[208:211], a[8:11], v[64:67], v[208:211]
    ds_read_b128 a[44:47], v225 offset:64512
    s_add_u32 s28, s52, 0
    v_mfma_f32_16x16x32_bf16 v[212:215], a[8:11], v[68:71], v[212:215]
    buffer_load_dwordx4 v[0:3], v228, s[36:39], s28 offen sc1
    v_add_f32_dpp v236, v236, v236 row_shr:4 row_mask:0xf bank_mask:0xf bound_ctrl:1
    v_mfma_f32_16x16x32_bf16 v[216:219], a[12:15], v[64:67], v[216:219]
    v_add_f32_dpp v237, v237, v237 row_shr:4 row_mask:0xf bank_mask:0xf bound_ctrl:1
    s_nop 0
    v_mfma_f32_16x16x32_bf16 v[220:223], a[12:15], v[68:71], v[220:223]
    v_add_f32_dpp v236, v236, v236 row_shr:8 row_mask:0xf bank_mask:0xf bound_ctrl:1
    s_waitcnt lgkmcnt(4)
    v_mfma_f32_16x16x32_bf16 v[192:195], a[16:19], v[72:75], v[192:195]
    ds_read_b128 a[0:3], v234 offset:0
    v_add_f32_dpp v237, v237, v237 row_shr:8 row_mask:0xf bank_mask:0xf bound_ctrl:1
    v_mfma_f32_16x16x32_bf16 v[196:199], a[16:19], v[76:79], v[196:199]
    ds_read_b128 a[4:7], v234 offset:1024
    s_nop 0
    v_mfma_f32_16x16x32_bf16 v[200:203], a[20:23], v[72:75], v[200:203]
    ds_read_b128 a[8:11], v234 offset:2048
    buffer_load_dwordx4 v[4:7], v229, s[36:39], s28 offen sc1
    v_mfma_f32_16x16x32_bf16 v[204:207], a[20:23], v[76:79], v[204:207]
    ds_read_b128 a[12:15], v234 offset:3072
    v_mul_f32 v236, 0x3acccccd, v236
    v_mfma_f32_16x16x32_bf16 v[208:211], a[24:27], v[72:75], v[208:211]
    v_mul_f32 v237, 0x3acccccd, v237
    v_fma_f32 v237, -v236, v236, v237
    v_mfma_f32_16x16x32_bf16 v[212:215], a[24:27], v[76:79], v[212:215]
    v_max_f32 v237, 0, v237
    v_cvt_pk_bf16_f32 v251, v237, v237
    v_mfma_f32_16x16x32_bf16 v[216:219], a[28:31], v[72:75], v[216:219]
    buffer_load_dwordx4 v[8:11], v230, s[36:39], s28 offen sc1
    v_and_b32 v251, 0xffff0000, v251
    v_mfma_f32_16x16x32_bf16 v[220:223], a[28:31], v[76:79], v[220:223]
    v_add_f32 v251, 0x3727c5ac, v251
    s_waitcnt lgkmcnt(4)
    v_mfma_f32_16x16x32_bf16 v[192:195], a[32:35], v[80:83], v[192:195]
    ds_read_b128 a[16:19], v234 offset:4096
    v_cvt_pk_bf16_f32 v251, v251, v251
    v_mfma_f32_16x16x32_bf16 v[196:199], a[32:35], v[84:87], v[196:199]
    ds_read_b128 a[20:23], v234 offset:5120
    v_and_b32 v251, 0xffff0000, v251
    v_mfma_f32_16x16x32_bf16 v[200:203], a[36:39], v[80:83], v[200:203]
    ds_read_b128 a[24:27], v234 offset:6144
    v_sqrt_f32 v251, v251
    v_mfma_f32_16x16x32_bf16 v[204:207], a[36:39], v[84:87], v[204:207]
    ds_read_b128 a[28:31], v234 offset:7168
    s_nop 0
    v_mfma_f32_16x16x32_bf16 v[208:211], a[40:43], v[80:83], v[208:211]
    buffer_load_dwordx4 v[12:15], v231, s[36:39], s28 offen sc1
    v_cvt_pk_bf16_f32 v238, v251, v236
    v_mfma_f32_16x16x32_bf16 v[212:215], a[40:43], v[84:87], v[212:215]
    v_lshlrev_b32 v238, 16, v238
    v_mul_f32 v238, v238, v238
    v_mfma_f32_16x16x32_bf16 v[216:219], a[44:47], v[80:83], v[216:219]
    v_rcp_f32 v238, v238
    s_nop 0
    v_mfma_f32_16x16x32_bf16 v[220:223], a[44:47], v[84:87], v[220:223]
    buffer_store_dwordx2 v[238:239], v250, s[36:39], 0 offen sc1
    s_waitcnt lgkmcnt(4)
    v_mfma_f32_16x16x32_bf16 v[192:195], a[0:3], v[88:91], v[192:195]
    ds_read_b128 a[32:35], v234 offset:8192
    v_mfma_f32_16x16x32_bf16 v[196:199], a[0:3], v[92:95], v[196:199]
    ds_read_b128 a[36:39], v234 offset:9216
    v_mfma_f32_16x16x32_bf16 v[200:203], a[4:7], v[88:91], v[200:203]
    ds_read_b128 a[40:43], v234 offset:10240
    s_add_u32 s28, s53, 0
    v_mfma_f32_16x16x32_bf16 v[204:207], a[4:7], v[92:95], v[204:207]
    ds_read_b128 a[44:47], v234 offset:11264
    buffer_load_dwordx4 v[16:19], v228, s[36:39], s28 offen sc1
    v_mfma_f32_16x16x32_bf16 v[208:211], a[8:11], v[88:91], v[208:211]
    v_mfma_f32_16x16x32_bf16 v[212:215], a[8:11], v[92:95], v[212:215]
    v_mfma_f32_16x16x32_bf16 v[216:219], a[12:15], v[88:91], v[216:219]
    buffer_load_dwordx4 v[20:23], v229, s[36:39], s28 offen sc1
    v_mfma_f32_16x16x32_bf16 v[220:223], a[12:15], v[92:95], v[220:223]
    s_waitcnt lgkmcnt(4)
    v_mfma_f32_16x16x32_bf16 v[192:195], a[16:19], v[96:99], v[192:195]
    ds_read_b128 a[0:3], v234 offset:12288
    v_mfma_f32_16x16x32_bf16 v[196:199], a[16:19], v[100:103], v[196:199]
    ds_read_b128 a[4:7], v234 offset:13312
    v_mfma_f32_16x16x32_bf16 v[200:203], a[20:23], v[96:99], v[200:203]
    ds_read_b128 a[8:11], v234 offset:14336
    v_mfma_f32_16x16x32_bf16 v[204:207], a[20:23], v[100:103], v[204:207]
    ds_read_b128 a[12:15], v234 offset:15360
    v_mfma_f32_16x16x32_bf16 v[208:211], a[24:27], v[96:99], v[208:211]
    buffer_load_dwordx4 v[24:27], v230, s[36:39], s28 offen sc1
    v_mfma_f32_16x16x32_bf16 v[212:215], a[24:27], v[100:103], v[212:215]
    v_mfma_f32_16x16x32_bf16 v[216:219], a[28:31], v[96:99], v[216:219]
    v_mfma_f32_16x16x32_bf16 v[220:223], a[28:31], v[100:103], v[220:223]
    s_waitcnt lgkmcnt(4)
    v_mfma_f32_16x16x32_bf16 v[192:195], a[32:35], v[104:107], v[192:195]
    s_barrier
    v_mfma_f32_16x16x32_bf16 v[196:199], a[32:35], v[108:111], v[196:199]
    ds_read_b128 a[16:19], v234 offset:16384
    v_mfma_f32_16x16x32_bf16 v[200:203], a[36:39], v[104:107], v[200:203]
    ds_read_b128 a[20:23], v234 offset:17408
    buffer_load_dwordx4 v[28:31], v231, s[36:39], s28 offen sc1
    v_mfma_f32_16x16x32_bf16 v[204:207], a[36:39], v[108:111], v[204:207]
    ds_read_b128 a[24:27], v234 offset:18432
    v_mfma_f32_16x16x32_bf16 v[208:211], a[40:43], v[104:107], v[208:211]
    ds_read_b128 a[28:31], v234 offset:19456
    v_mfma_f32_16x16x32_bf16 v[212:215], a[40:43], v[108:111], v[212:215]
    v_mfma_f32_16x16x32_bf16 v[216:219], a[44:47], v[104:107], v[216:219]
    s_add_u32 s28, s54, 0
    buffer_load_dwordx4 v[32:35], v228, s[36:39], s28 offen sc1
    v_mfma_f32_16x16x32_bf16 v[220:223], a[44:47], v[108:111], v[220:223]
    s_waitcnt lgkmcnt(4)
    v_mfma_f32_16x16x32_bf16 v[192:195], a[0:3], v[112:115], v[192:195]
    ds_read_b128 a[32:35], v234 offset:20480
    v_mfma_f32_16x16x32_bf16 v[196:199], a[0:3], v[116:119], v[196:199]
    ds_read_b128 a[36:39], v234 offset:21504
    v_mfma_f32_16x16x32_bf16 v[200:203], a[4:7], v[112:115], v[200:203]
    ds_read_b128 a[40:43], v234 offset:22528
    v_mfma_f32_16x16x32_bf16 v[204:207], a[4:7], v[116:119], v[204:207]
    ds_read_b128 a[44:47], v234 offset:23552
    v_mfma_f32_16x16x32_bf16 v[208:211], a[8:11], v[112:115], v[208:211]
    buffer_load_dwordx4 v[36:39], v229, s[36:39], s28 offen sc1
    v_mfma_f32_16x16x32_bf16 v[212:215], a[8:11], v[116:119], v[212:215]
    v_mfma_f32_16x16x32_bf16 v[216:219], a[12:15], v[112:115], v[216:219]
    v_mfma_f32_16x16x32_bf16 v[220:223], a[12:15], v[116:119], v[220:223]
    s_waitcnt lgkmcnt(4)
    v_mfma_f32_16x16x32_bf16 v[192:195], a[16:19], v[120:123], v[192:195]
    ds_read_b128 a[0:3], v234 offset:24576
    v_mfma_f32_16x16x32_bf16 v[196:199], a[16:19], v[124:127], v[196:199]
    ds_read_b128 a[4:7], v234 offset:25600
    v_mfma_f32_16x16x32_bf16 v[200:203], a[20:23], v[120:123], v[200:203]
    ds_read_b128 a[8:11], v234 offset:26624
    buffer_load_dwordx4 v[40:43], v230, s[36:39], s28 offen sc1
    v_mfma_f32_16x16x32_bf16 v[204:207], a[20:23], v[124:127], v[204:207]
    ds_read_b128 a[12:15], v234 offset:27648
    v_mfma_f32_16x16x32_bf16 v[208:211], a[24:27], v[120:123], v[208:211]
    v_mfma_f32_16x16x32_bf16 v[212:215], a[24:27], v[124:127], v[212:215]
    v_mfma_f32_16x16x32_bf16 v[216:219], a[28:31], v[120:123], v[216:219]
    buffer_load_dwordx4 v[44:47], v231, s[36:39], s28 offen sc1
    v_mfma_f32_16x16x32_bf16 v[220:223], a[28:31], v[124:127], v[220:223]
    s_waitcnt lgkmcnt(4)
    v_mfma_f32_16x16x32_bf16 v[192:195], a[32:35], v[128:131], v[192:195]
    ds_read_b128 a[16:19], v234 offset:28672
    v_mfma_f32_16x16x32_bf16 v[196:199], a[32:35], v[132:135], v[196:199]
    ds_read_b128 a[20:23], v234 offset:29696
    v_mfma_f32_16x16x32_bf16 v[200:203], a[36:39], v[128:131], v[200:203]
    ds_read_b128 a[24:27], v234 offset:30720
    v_mfma_f32_16x16x32_bf16 v[204:207], a[36:39], v[132:135], v[204:207]
    ds_read_b128 a[28:31], v234 offset:31744
    v_mfma_f32_16x16x32_bf16 v[208:211], a[40:43], v[128:131], v[208:211]
    s_add_u32 s28, s55, 0
    buffer_load_dwordx4 v[48:51], v228, s[36:39], s28 offen sc1
    v_mfma_f32_16x16x32_bf16 v[212:215], a[40:43], v[132:135], v[212:215]
    v_mfma_f32_16x16x32_bf16 v[216:219], a[44:47], v[128:131], v[216:219]
    v_mfma_f32_16x16x32_bf16 v[220:223], a[44:47], v[132:135], v[220:223]
    s_waitcnt lgkmcnt(4)
    v_mfma_f32_16x16x32_bf16 v[192:195], a[0:3], v[136:139], v[192:195]
    ds_read_b128 a[32:35], v234 offset:32768
    v_mfma_f32_16x16x32_bf16 v[196:199], a[0:3], v[140:143], v[196:199]
    ds_read_b128 a[36:39], v234 offset:33792
    v_mfma_f32_16x16x32_bf16 v[200:203], a[4:7], v[136:139], v[200:203]
    ds_read_b128 a[40:43], v234 offset:34816
    buffer_load_dwordx4 v[52:55], v229, s[36:39], s28 offen sc1
    v_mfma_f32_16x16x32_bf16 v[204:207], a[4:7], v[140:143], v[204:207]
    ds_read_b128 a[44:47], v234 offset:35840
    v_mfma_f32_16x16x32_bf16 v[208:211], a[8:11], v[136:139], v[208:211]
    v_mfma_f32_16x16x32_bf16 v[212:215], a[8:11], v[140:143], v[212:215]
    v_mfma_f32_16x16x32_bf16 v[216:219], a[12:15], v[136:139], v[216:219]
    buffer_load_dwordx4 v[56:59], v230, s[36:39], s28 offen sc1
    v_mfma_f32_16x16x32_bf16 v[220:223], a[12:15], v[140:143], v[220:223]
    s_waitcnt lgkmcnt(4)
    v_mfma_f32_16x16x32_bf16 v[192:195], a[16:19], v[144:147], v[192:195]
    v_mfma_f32_16x16x32_bf16 v[196:199], a[16:19], v[148:151], v[196:199]
    v_mfma_f32_16x16x32_bf16 v[200:203], a[20:23], v[144:147], v[200:203]
    v_mfma_f32_16x16x32_bf16 v[204:207], a[20:23], v[148:151], v[204:207]
    v_mfma_f32_16x16x32_bf16 v[208:211], a[24:27], v[144:147], v[208:211]
    buffer_load_dwordx4 v[60:63], v231, s[36:39], s28 offen sc1
    v_mfma_f32_16x16x32_bf16 v[212:215], a[24:27], v[148:151], v[212:215]
    v_mfma_f32_16x16x32_bf16 v[216:219], a[28:31], v[144:147], v[216:219]
    v_mfma_f32_16x16x32_bf16 v[220:223], a[28:31], v[148:151], v[220:223]
    s_waitcnt lgkmcnt(0)
    v_mfma_f32_16x16x32_bf16 v[192:195], a[32:35], v[152:155], v[192:195]
    v_mfma_f32_16x16x32_bf16 v[196:199], a[32:35], v[156:159], v[196:199]
    v_mfma_f32_16x16x32_bf16 v[200:203], a[36:39], v[152:155], v[200:203]
    s_add_u32 s28, s52, 16384
    buffer_load_dwordx4 v[64:67], v228, s[36:39], s28 offen sc1
    v_mfma_f32_16x16x32_bf16 v[204:207], a[36:39], v[156:159], v[204:207]
    v_mfma_f32_16x16x32_bf16 v[208:211], a[40:43], v[152:155], v[208:211]
    v_mfma_f32_16x16x32_bf16 v[212:215], a[40:43], v[156:159], v[212:215]
    v_mfma_f32_16x16x32_bf16 v[216:219], a[44:47], v[152:155], v[216:219]
    buffer_load_dwordx4 v[68:71], v229, s[36:39], s28 offen sc1
    v_mfma_f32_16x16x32_bf16 v[220:223], a[44:47], v[156:159], v[220:223]
    buffer_load_dwordx4 v[72:75], v230, s[36:39], s28 offen sc1
    buffer_load_dwordx4 v[76:79], v231, s[36:39], s28 offen sc1
    s_waitcnt vmcnt(17)
    v_max_u32 v248, v0, v2
    v_max3_u32 v248, v4, v6, v248
    v_max3_u32 v248, v8, v10, v248
    v_max3_u32 v248, v12, v14, v248
    v_cmp_eq_u32 vcc, s92, v248
    s_nop 0
    s_cbranch_vccnz L_mre0
L_mre0_ok:
    v_mfma_f32_16x16x32_bf16 v[112:115], a[48:51], v[0:3], 0
    v_mul_f32 v192, v192, v208
    v_mul_f32 v193, v193, v209
    v_mfma_f32_16x16x32_bf16 v[132:135], a[48:51], v[4:7], 0
    s_add_u32 s28, s53, 16384
    buffer_load_dwordx4 v[80:83], v228, s[36:39], s28 offen sc1
    v_mfma_f32_16x16x32_bf16 v[152:155], a[48:51], v[8:11], 0
    v_mul_f32 v194, v194, v210
    v_mul_f32 v195, v195, v211
    v_mfma_f32_16x16x32_bf16 v[172:175], a[48:51], v[12:15], 0
    v_cvt_pk_bf16_f32 v240, v192, v193
    v_cvt_pk_bf16_f32 v241, v194, v195
    v_mfma_f32_16x16x32_bf16 v[116:119], a[52:55], v[0:3], 0
    buffer_load_dwordx4 v[84:87], v229, s[36:39], s28 offen sc1
    v_mul_f32 v200, v200, v216
    v_mfma_f32_16x16x32_bf16 v[136:139], a[52:55], v[4:7], 0
    v_mul_f32 v201, v201, v217
    v_mul_f32 v202, v202, v218
    v_mfma_f32_16x16x32_bf16 v[156:159], a[52:55], v[8:11], 0
    v_mul_f32 v203, v203, v219
    v_cvt_pk_bf16_f32 v242, v200, v201
    v_mfma_f32_16x16x32_bf16 v[176:179], a[52:55], v[12:15], 0
    buffer_load_dwordx4 v[88:91], v230, s[36:39], s28 offen sc1
    v_cvt_pk_bf16_f32 v243, v202, v203
    v_mfma_f32_16x16x32_bf16 v[120:123], a[56:59], v[0:3], 0
    buffer_store_dwordx4 v[240:243], v225, s[36:39], s3 offen sc1
    v_mul_f32 v196, v196, v212
    v_mfma_f32_16x16x32_bf16 v[140:143], a[56:59], v[4:7], 0
    v_mul_f32 v197, v197, v213
    v_mul_f32 v198, v198, v214
    v_mfma_f32_16x16x32_bf16 v[160:163], a[56:59], v[8:11], 0
    buffer_load_dwordx4 v[92:95], v231, s[36:39], s28 offen sc1
    v_mul_f32 v199, v199, v215
    v_mfma_f32_16x16x32_bf16 v[180:183], a[56:59], v[12:15], 0
    v_cvt_pk_bf16_f32 v244, v196, v197
    v_mfma_f32_16x16x32_bf16 v[124:127], a[60:63], v[0:3], 0
    s_waitcnt vmcnt(17)
    v_max_u32 v248, v16, v18
    v_mfma_f32_16x16x32_bf16 v[144:147], a[60:63], v[4:7], 0
    s_add_u32 s28, s54, 16384
    buffer_load_dwordx4 v[96:99], v228, s[36:39], s28 offen sc1
    v_mfma_f32_16x16x32_bf16 v[164:167], a[60:63], v[8:11], 0
    v_max3_u32 v248, v20, v22, v248
    v_max3_u32 v248, v24, v26, v248
    v_mfma_f32_16x16x32_bf16 v[184:187], a[60:63], v[12:15], 0
    v_max3_u32 v248, v28, v30, v248
    v_cmp_eq_u32 vcc, s92, v248
    v_mfma_f32_16x16x32_bf16 v[128:131], a[64:67], v[0:3], 0
    buffer_load_dwordx4 v[100:103], v229, s[36:39], s28 offen sc1
    v_mfma_f32_16x16x32_bf16 v[148:151], a[64:67], v[4:7], 0
    s_cbranch_vccnz L_mre1
L_mre1_ok:
    v_mfma_f32_16x16x32_bf16 v[168:171], a[64:67], v[8:11], 0
    v_cvt_pk_bf16_f32 v245, v198, v199
    v_mul_f32 v204, v204, v220
    v_mfma_f32_16x16x32_bf16 v[188:191], a[64:67], v[12:15], 0
    v_mul_f32 v205, v205, v221
    v_mfma_f32_16x16x32_bf16 v[112:115], a[68:71], v[16:19], v[112:115]
    v_mul_f32 v206, v206, v222
    v_mul_f32 v207, v207, v223
    v_mfma_f32_16x16x32_bf16 v[132:135], a[68:71], v[20:23], v[132:135]
    buffer_load_dwordx4 v[104:107], v230, s[36:39], s28 offen sc1
    v_cvt_pk_bf16_f32 v246, v204, v205
    v_mfma_f32_16x16x32_bf16 v[152:155], a[68:71], v[24:27], v[152:155]
    v_cvt_pk_bf16_f32 v247, v206, v207
    v_mfma_f32_16x16x32_bf16 v[172:175], a[68:71], v[28:31], v[172:175]
    buffer_store_dwordx4 v[244:247], v225, s[36:39], s31 offen sc1
    s_add_u32 s3, s3, 16384
    v_mfma_f32_16x16x32_bf16 v[116:119], a[72:75], v[16:19], v[116:119]
    buffer_load_dwordx4 v[108:111], v231, s[36:39], s28 offen sc1
    s_add_u32 s31, s31, 16384
    v_mfma_f32_16x16x32_bf16 v[136:139], a[72:75], v[20:23], v[136:139]
    v_mfma_f32_16x16x32_bf16 v[156:159], a[72:75], v[24:27], v[156:159]
    v_mfma_f32_16x16x32_bf16 v[176:179], a[72:75], v[28:31], v[176:179]
    s_add_u32 s28, s55, 16384
    buffer_load_dwordx4 v[0:3], v228, s[36:39], s28 offen sc1
    v_mfma_f32_16x16x32_bf16 v[120:123], a[76:79], v[16:19], v[120:123]
    v_mfma_f32_16x16x32_bf16 v[140:143], a[76:79], v[20:23], v[140:143]
    v_mfma_f32_16x16x32_bf16 v[160:163], a[76:79], v[24:27], v[160:163]
    buffer_load_dwordx4 v[4:7], v229, s[36:39], s28 offen sc1
    v_mfma_f32_16x16x32_bf16 v[180:183], a[76:79], v[28:31], v[180:183]
    v_mfma_f32_16x16x32_bf16 v[124:127], a[80:83], v[16:19], v[124:127]
    s_waitcnt vmcnt(20)
    v_max_u32 v248, v32, v34
    v_mfma_f32_16x16x32_bf16 v[144:147], a[80:83], v[20:23], v[144:147]
    buffer_load_dwordx4 v[8:11], v230, s[36:39], s28 offen sc1
    v_max3_u32 v248, v36, v38, v248
    v_mfma_f32_16x16x32_bf16 v[164:167], a[80:83], v[24:27], v[164:167]
    v_max3_u32 v248, v40, v42, v248
    v_max3_u32 v248, v44, v46, v248
    v_mfma_f32_16x16x32_bf16 v[184:187], a[80:83], v[28:31], v[184:187]
    v_cmp_eq_u32 vcc, s92, v248
    v_mfma_f32_16x16x32_bf16 v[128:131], a[84:87], v[16:19], v[128:131]
    buffer_load_dwordx4 v[12:15], v231, s[36:39], s28 offen sc1
    v_mfma_f32_16x16x32_bf16 v[148:151], a[84:87], v[20:23], v[148:151]
    s_cbranch_vccnz L_mre2
L_mre2_ok:
    v_mfma_f32_16x16x32_bf16 v[168:171], a[84:87], v[24:27], v[168:171]
    v_mfma_f32_16x16x32_bf16 v[188:191], a[84:87], v[28:31], v[188:191]
    v_mfma_f32_16x16x32_bf16 v[112:115], a[88:91], v[32:35], v[112:115]
    v_and_b32 v192, 15, v224
    v_lshrrev_b32 v193, 4, v224
    v_mfma_f32_16x16x32_bf16 v[132:135], a[88:91], v[36:39], v[132:135]
    s_add_u32 s30, s50, 163840
    buffer_load_dwordx4 a[0:3], v225, s[36:39], s30 offen offset:0 sc1
    v_mfma_f32_16x16x32_bf16 v[152:155], a[88:91], v[40:43], v[152:155]
    s_lshl_b32 s70, s100, 6
    s_lshl_b32 s71, s61, 4
    v_mfma_f32_16x16x32_bf16 v[172:175], a[88:91], v[44:47], v[172:175]
    s_add_u32 s70, s70, s71
    v_add_u32 v194, s70, v192
    v_mfma_f32_16x16x32_bf16 v[116:119], a[92:95], v[32:35], v[116:119]
    buffer_load_dwordx4 a[4:7], v225, s[36:39], s30 offen offset:1024 sc1
    v_lshlrev_b32 v194, 3, v194
    v_mfma_f32_16x16x32_bf16 v[136:139], a[92:95], v[36:39], v[136:139]
    v_add_u32 v194, 163840, v194
    s_lshr_b32 s70, s70, 5
    v_mfma_f32_16x16x32_bf16 v[156:159], a[92:95], v[40:43], v[156:159]
    s_lshl_b32 s70, s70, 4
    v_add_u32 v192, s70, v192
    v_mfma_f32_16x16x32_bf16 v[176:179], a[92:95], v[44:47], v[176:179]
    buffer_load_dwordx4 a[8:11], v225, s[36:39], s30 offen offset:2048 sc1
    s_mul_i32 s71, s101, 20
    v_mfma_f32_16x16x32_bf16 v[120:123], a[96:99], v[32:35], v[120:123]
    v_add_u32 v195, s71, v193
    v_lshlrev_b32 v195, 14, v195
    v_mfma_f32_16x16x32_bf16 v[140:143], a[96:99], v[36:39], v[140:143]
    v_lshl_add_u32 v195, v192, 4, v195
    s_and_b32 s71, s61, 1
    v_mfma_f32_16x16x32_bf16 v[160:163], a[96:99], v[40:43], v[160:163]
    buffer_load_dwordx4 a[12:15], v225, s[36:39], s30 offen offset:3072 sc1
    s_lshl_b32 s70, s71, 3
    v_mfma_f32_16x16x32_bf16 v[180:183], a[96:99], v[44:47], v[180:183]
    s_add_u32 s70, s70, 1048576
    v_mfma_f32_16x16x32_bf16 v[124:127], a[100:103], v[32:35], v[124:127]
    s_waitcnt vmcnt(22)
    v_max_u32 v248, v48, v50
    v_mfma_f32_16x16x32_bf16 v[144:147], a[100:103], v[36:39], v[144:147]
    buffer_load_dwordx4 a[16:19], v227, s[36:39], s30 offen sc1
    v_max3_u32 v248, v52, v54, v248
    v_mfma_f32_16x16x32_bf16 v[164:167], a[100:103], v[40:43], v[164:167]
    v_max3_u32 v248, v56, v58, v248
    v_max3_u32 v248, v60, v62, v248
    v_mfma_f32_16x16x32_bf16 v[184:187], a[100:103], v[44:47], v[184:187]
    v_cmp_eq_u32 vcc, s92, v248
    v_mfma_f32_16x16x32_bf16 v[128:131], a[104:107], v[32:35], v[128:131]
    s_add_u32 s30, s51, 163840
    buffer_load_dwordx4 a[20:23], v225, s[36:39], s30 offen offset:0 sc1
    v_mfma_f32_16x16x32_bf16 v[148:151], a[104:107], v[36:39], v[148:151]
    s_cbranch_vccnz L_mre3
L_mre3_ok:
    v_mfma_f32_16x16x32_bf16 v[168:171], a[104:107], v[40:43], v[168:171]
    s_mov_b32 s66, s70
    v_lshrrev_b32 v221, 8, v192
    v_mfma_f32_16x16x32_bf16 v[188:191], a[104:107], v[44:47], v[188:191]
    v_lshlrev_b32 v221, 9, v221
    v_mfma_f32_16x16x32_bf16 v[112:115], a[108:111], v[48:51], v[112:115]
    v_and_b32 v196, 63, v192
    v_lshl_add_u32 v221, v196, 3, v221
    v_mfma_f32_16x16x32_bf16 v[132:135], a[108:111], v[52:55], v[132:135]
    buffer_load_dwordx4 a[24:27], v225, s[36:39], s30 offen offset:1024 sc1
    v_bfe_u32 v196, v192, 6, 2
    v_mfma_f32_16x16x32_bf16 v[152:155], a[108:111], v[56:59], v[152:155]
    v_lshl_add_u32 v221, v196, 1, v221
    v_add_u32 v221, s71, v221
    v_mfma_f32_16x16x32_bf16 v[172:175], a[108:111], v[60:63], v[172:175]
    v_mul_u32_u24 v221, 1280, v221
    v_lshl_add_u32 v221, v193, 3, v221
    v_mfma_f32_16x16x32_bf16 v[116:119], a[112:115], v[48:51], v[116:119]
    buffer_load_dwordx4 a[28:31], v225, s[36:39], s30 offen offset:2048 sc1
    s_mul_i32 s70, s101, 160
    v_mfma_f32_16x16x32_bf16 v[136:139], a[112:115], v[52:55], v[136:139]
    v_add_u32 v221, s70, v221
    s_add_u32 s70, s61, 1
    v_mfma_f32_16x16x32_bf16 v[156:159], a[112:115], v[56:59], v[156:159]
    s_and_b32 s70, s70, 3
    s_mul_i32 s70, s70, 15360
    v_mfma_f32_16x16x32_bf16 v[176:179], a[112:115], v[60:63], v[176:179]
    buffer_load_dwordx4 a[32:35], v225, s[36:39], s30 offen offset:3072 sc1
    s_add_u32 s70, s70, 0
    v_mfma_f32_16x16x32_bf16 v[120:123], a[116:119], v[48:51], v[120:123]
    v_add_u32 v208, s70, v225
    s_add_u32 s70, s61, 2
    v_mfma_f32_16x16x32_bf16 v[140:143], a[116:119], v[52:55], v[140:143]
    s_and_b32 s70, s70, 3
    s_mul_i32 s70, s70, 15360
    v_mfma_f32_16x16x32_bf16 v[160:163], a[116:119], v[56:59], v[160:163]
    buffer_load_dwordx4 a[36:39], v227, s[36:39], s30 offen sc1
    s_add_u32 s70, s70, 5120
    v_mfma_f32_16x16x32_bf16 v[180:183], a[116:119], v[60:63], v[180:183]
    v_add_u32 v209, s70, v225
    v_mfma_f32_16x16x32_bf16 v[124:127], a[120:123], v[48:51], v[124:127]
    s_waitcnt vmcnt(24)
    v_max_u32 v248, v64, v66
    v_mfma_f32_16x16x32_bf16 v[144:147], a[120:123], v[52:55], v[144:147]
    buffer_load_dwordx2 v[198:199], v195, s[36:39], s66 offen sc1
    s_add_u32 s66, s66, 0x10000
    v_mfma_f32_16x16x32_bf16 v[164:167], a[120:123], v[56:59], v[164:167]
    v_max3_u32 v248, v68, v70, v248
    v_max3_u32 v248, v72, v74, v248
    v_mfma_f32_16x16x32_bf16 v[184:187], a[120:123], v[60:63], v[184:187]
    v_max3_u32 v248, v76, v78, v248
    v_cmp_eq_u32 vcc, s92, v248
    v_mfma_f32_16x16x32_bf16 v[128:131], a[124:127], v[48:51], v[128:131]
    buffer_load_dwordx2 v[200:201], v195, s[36:39], s66 offen sc1
    s_add_u32 s66, s66, 0x10000
    v_mfma_f32_16x16x32_bf16 v[148:151], a[124:127], v[52:55], v[148:151]
    s_cbranch_vccnz L_mre4
L_mre4_ok:
    v_mfma_f32_16x16x32_bf16 v[168:171], a[124:127], v[56:59], v[168:171]
    s_add_u32 s70, s61, 3
    s_and_b32 s70, s70, 3
    v_mfma_f32_16x16x32_bf16 v[188:191], a[124:127], v[60:63], v[188:191]
    s_mul_i32 s70, s70, 15360
    v_mfma_f32_16x16x32_bf16 v[112:115], a[128:131], v[64:67], v[112:115]
    s_add_u32 s70, s70, 10240
    v_add_u32 v210, s70, v225
    v_mfma_f32_16x16x32_bf16 v[132:135], a[128:131], v[68:71], v[132:135]
    buffer_load_dwordx2 v[202:203], v195, s[36:39], s66 offen sc1
    s_add_u32 s66, s66, 0x10000
    v_mfma_f32_16x16x32_bf16 v[152:155], a[128:131], v[72:75], v[152:155]
    s_mul_i32 s70, s61, 15360
    v_add_u32 v211, s70, v225
    v_mfma_f32_16x16x32_bf16 v[172:175], a[128:131], v[76:79], v[172:175]
    v_mfma_f32_16x16x32_bf16 v[116:119], a[132:135], v[64:67], v[116:119]
    v_mfma_f32_16x16x32_bf16 v[136:139], a[132:135], v[68:71], v[136:139]
    v_mfma_f32_16x16x32_bf16 v[156:159], a[132:135], v[72:75], v[156:159]
    v_mfma_f32_16x16x32_bf16 v[176:179], a[132:135], v[76:79], v[176:179]
    v_mfma_f32_16x16x32_bf16 v[120:123], a[136:139], v[64:67], v[120:123]
    v_mfma_f32_16x16x32_bf16 v[140:143], a[136:139], v[68:71], v[140:143]
    v_mfma_f32_16x16x32_bf16 v[160:163], a[136:139], v[72:75], v[160:163]
    buffer_load_dwordx2 v[204:205], v195, s[36:39], s66 offen sc1
    s_add_u32 s66, s66, 0x10000
    v_mfma_f32_16x16x32_bf16 v[180:183], a[136:139], v[76:79], v[180:183]
    v_mfma_f32_16x16x32_bf16 v[124:127], a[140:143], v[64:67], v[124:127]
    s_waitcnt vmcnt(23)
    v_max_u32 v248, v80, v82
    v_mfma_f32_16x16x32_bf16 v[144:147], a[140:143], v[68:71], v[144:147]
    v_max3_u32 v248, v84, v86, v248
    v_max3_u32 v248, v88, v90, v248
    v_mfma_f32_16x16x32_bf16 v[164:167], a[140:143], v[72:75], v[164:167]
    v_max3_u32 v248, v92, v94, v248
    v_cmp_eq_u32 vcc, s92, v248
    v_mfma_f32_16x16x32_bf16 v[184:187], a[140:143], v[76:79], v[184:187]
    s_cbranch_vccnz L_mre5
L_mre5_ok:
    v_mfma_f32_16x16x32_bf16 v[128:131], a[144:147], v[64:67], v[128:131]
    v_mfma_f32_16x16x32_bf16 v[148:151], a[144:147], v[68:71], v[148:151]
    v_mfma_f32_16x16x32_bf16 v[168:171], a[144:147], v[72:75], v[168:171]
    v_mfma_f32_16x16x32_bf16 v[188:191], a[144:147], v[76:79], v[188:191]
    v_mfma_f32_16x16x32_bf16 v[112:115], a[148:151], v[80:83], v[112:115]
    v_mfma_f32_16x16x32_bf16 v[132:135], a[148:151], v[84:87], v[132:135]
    s_add_u32 s28, s52, 32768
    buffer_load_dwordx4 v[16:19], v228, s[36:39], s28 offen sc1
    v_mfma_f32_16x16x32_bf16 v[152:155], a[148:151], v[88:91], v[152:155]
    v_mfma_f32_16x16x32_bf16 v[172:175], a[148:151], v[92:95], v[172:175]
    v_mfma_f32_16x16x32_bf16 v[116:119], a[152:155], v[80:83], v[116:119]
    buffer_load_dwordx4 v[20:23], v229, s[36:39], s28 offen sc1
    v_mfma_f32_16x16x32_bf16 v[136:139], a[152:155], v[84:87], v[136:139]
    v_mfma_f32_16x16x32_bf16 v[156:159], a[152:155], v[88:91], v[156:159]
    v_mfma_f32_16x16x32_bf16 v[176:179], a[152:155], v[92:95], v[176:179]
    buffer_load_dwordx4 v[24:27], v230, s[36:39], s28 offen sc1
    v_mfma_f32_16x16x32_bf16 v[120:123], a[156:159], v[80:83], v[120:123]
    v_mfma_f32_16x16x32_bf16 v[140:143], a[156:159], v[84:87], v[140:143]
    v_mfma_f32_16x16x32_bf16 v[160:163], a[156:159], v[88:91], v[160:163]
    buffer_load_dwordx4 v[28:31], v231, s[36:39], s28 offen sc1
    v_mfma_f32_16x16x32_bf16 v[180:183], a[156:159], v[92:95], v[180:183]
    v_mfma_f32_16x16x32_bf16 v[124:127], a[160:163], v[80:83], v[124:127]
    s_waitcnt vmcnt(22)
    v_max_u32 v248, v96, v98
    v_mfma_f32_16x16x32_bf16 v[144:147], a[160:163], v[84:87], v[144:147]
    buffer_load_dwordx2 v[206:207], v195, s[36:39], s66 offen sc1
    s_add_u32 s66, s66, 0x10000
    v_mfma_f32_16x16x32_bf16 v[164:167], a[160:163], v[88:91], v[164:167]
    v_max3_u32 v248, v100, v102, v248
    v_max3_u32 v248, v104, v106, v248
    v_mfma_f32_16x16x32_bf16 v[184:187], a[160:163], v[92:95], v[184:187]
    v_max3_u32 v248, v108, v110, v248
    v_cmp_eq_u32 vcc, s92, v248
    v_mfma_f32_16x16x32_bf16 v[128:131], a[164:167], v[80:83], v[128:131]
    s_cbranch_vccnz L_mre6
L_mre6_ok:
    v_mfma_f32_16x16x32_bf16 v[148:151], a[164:167], v[84:87], v[148:151]
    v_mfma_f32_16x16x32_bf16 v[168:171], a[164:167], v[88:91], v[168:171]
    v_mfma_f32_16x16x32_bf16 v[188:191], a[164:167], v[92:95], v[188:191]
    v_mfma_f32_16x16x32_bf16 v[112:115], a[168:171], v[96:99], v[112:115]
    v_mfma_f32_16x16x32_bf16 v[132:135], a[168:171], v[100:103], v[132:135]
    s_add_u32 s28, s53, 32768
    buffer_load_dwordx4 v[32:35], v228, s[36:39], s28 offen sc1
    v_mfma_f32_16x16x32_bf16 v[152:155], a[168:171], v[104:107], v[152:155]
    v_mfma_f32_16x16x32_bf16 v[172:175], a[168:171], v[108:111], v[172:175]
    v_mfma_f32_16x16x32_bf16 v[116:119], a[172:175], v[96:99], v[116:119]
    v_mfma_f32_16x16x32_bf16 v[136:139], a[172:175], v[100:103], v[136:139]
    buffer_load_dwordx4 v[36:39], v229, s[36:39], s28 offen sc1
    v_mfma_f32_16x16x32_bf16 v[156:159], a[172:175], v[104:107], v[156:159]
    v_mfma_f32_16x16x32_bf16 v[176:179], a[172:175], v[108:111], v[176:179]
    v_mfma_f32_16x16x32_bf16 v[120:123], a[176:179], v[96:99], v[120:123]
    v_mfma_f32_16x16x32_bf16 v[140:143], a[176:179], v[100:103], v[140:143]
    buffer_load_dwordx4 v[40:43], v230, s[36:39], s28 offen sc1
    v_mfma_f32_16x16x32_bf16 v[160:163], a[176:179], v[104:107], v[160:163]
    v_mfma_f32_16x16x32_bf16 v[180:183], a[176:179], v[108:111], v[180:183]
    v_mfma_f32_16x16x32_bf16 v[124:127], a[180:183], v[96:99], v[124:127]
    s_waitcnt vmcnt(22)
    v_max_u32 v248, v0, v2
    v_mfma_f32_16x16x32_bf16 v[144:147], a[180:183], v[100:103], v[144:147]
    buffer_load_dwordx4 v[44:47], v231, s[36:39], s28 offen sc1
    v_max3_u32 v248, v4, v6, v248
    v_mfma_f32_16x16x32_bf16 v[164:167], a[180:183], v[104:107], v[164:167]
    v_max3_u32 v248, v8, v10, v248
    v_max3_u32 v248, v12, v14, v248
    v_mfma_f32_16x16x32_bf16 v[184:187], a[180:183], v[108:111], v[184:187]
    v_cmp_eq_u32 vcc, s92, v248
    v_mfma_f32_16x16x32_bf16 v[128:131], a[184:187], v[96:99], v[128:131]
    s_cbranch_vccnz L_mre7
L_mre7_ok:
    v_mfma_f32_16x16x32_bf16 v[148:151], a[184:187], v[100:103], v[148:151]
    v_mfma_f32_16x16x32_bf16 v[168:171], a[184:187], v[104:107], v[168:171]
    v_mfma_f32_16x16x32_bf16 v[188:191], a[184:187], v[108:111], v[188:191]
    v_mfma_f32_16x16x32_bf16 v[112:115], a[188:191], v[0:3], v[112:115]
    v_mfma_f32_16x16x32_bf16 v[132:135], a[188:191], v[4:7], v[132:135]
    s_add_u32 s28, s54, 32768
    buffer_load_dwordx4 v[48:51], v228, s[36:39], s28 offen sc1
    v_mfma_f32_16x16x32_bf16 v[152:155], a[188:191], v[8:11], v[152:155]
    v_mfma_f32_16x16x32_bf16 v[172:175], a[188:191], v[12:15], v[172:175]
    v_mfma_f32_16x16x32_bf16 v[116:119], a[192:195], v[0:3], v[116:119]
    v_mfma_f32_16x16x32_bf16 v[136:139], a[192:195], v[4:7], v[136:139]
    buffer_load_dwordx4 v[52:55], v229, s[36:39], s28 offen sc1
    v_mfma_f32_16x16x32_bf16 v[156:159], a[192:195], v[8:11], v[156:159]
    v_mfma_f32_16x16x32_bf16 v[176:179], a[192:195], v[12:15], v[176:179]
    v_mfma_f32_16x16x32_bf16 v[120:123], a[196:199], v[0:3], v[120:123]
    v_mfma_f32_16x16x32_bf16 v[140:143], a[196:199], v[4:7], v[140:143]
    buffer_load_dwordx4 v[56:59], v230, s[36:39], s28 offen sc1
    v_mfma_f32_16x16x32_bf16 v[160:163], a[196:199], v[8:11], v[160:163]
    v_mfma_f32_16x16x32_bf16 v[180:183], a[196:199], v[12:15], v[180:183]
    v_mfma_f32_16x16x32_bf16 v[124:127], a[200:203], v[0:3], v[124:127]
    s_waitcnt vmcnt(8)
    v_max_u32 v248, v16, v18
    v_mfma_f32_16x16x32_bf16 v[144:147], a[200:203], v[4:7], v[144:147]
    buffer_load_dwordx4 v[60:63], v231, s[36:39], s28 offen sc1
    v_max3_u32 v248, v20, v22, v248
    v_mfma_f32_16x16x32_bf16 v[164:167], a[200:203], v[8:11], v[164:167]
    v_max3_u32 v248, v24, v26, v248
    v_max3_u32 v248, v28, v30, v248
    v_mfma_f32_16x16x32_bf16 v[184:187], a[200:203], v[12:15], v[184:187]
    v_cmp_eq_u32 vcc, s92, v248
    v_mfma_f32_16x16x32_bf16 v[128:131], a[204:207], v[0:3], v[128:131]
    s_cbranch_vccnz L_mre8
L_mre8_ok:
    v_mfma_f32_16x16x32_bf16 v[148:151], a[204:207], v[4:7], v[148:151]
    v_mfma_f32_16x16x32_bf16 v[168:171], a[204:207], v[8:11], v[168:171]
    v_mfma_f32_16x16x32_bf16 v[188:191], a[204:207], v[12:15], v[188:191]
    v_mfma_f32_16x16x32_bf16 v[112:115], a[208:211], v[16:19], v[112:115]
    v_mfma_f32_16x16x32_bf16 v[132:135], a[208:211], v[20:23], v[132:135]
    s_add_u32 s28, s55, 32768
    buffer_load_dwordx4 v[64:67], v228, s[36:39], s28 offen sc1
    v_mfma_f32_16x16x32_bf16 v[152:155], a[208:211], v[24:27], v[152:155]
    v_mfma_f32_16x16x32_bf16 v[172:175], a[208:211], v[28:31], v[172:175]
    v_mfma_f32_16x16x32_bf16 v[116:119], a[212:215], v[16:19], v[116:119]
    v_mfma_f32_16x16x32_bf16 v[136:139], a[212:215], v[20:23], v[136:139]
    buffer_load_dwordx4 v[68:71], v229, s[36:39], s28 offen sc1
    v_mfma_f32_16x16x32_bf16 v[156:159], a[212:215], v[24:27], v[156:159]
    v_mfma_f32_16x16x32_bf16 v[176:179], a[212:215], v[28:31], v[176:179]
    v_mfma_f32_16x16x32_bf16 v[120:123], a[216:219], v[16:19], v[120:123]
    v_mfma_f32_16x16x32_bf16 v[140:143], a[216:219], v[20:23], v[140:143]
    buffer_load_dwordx4 v[72:75], v230, s[36:39], s28 offen sc1
    v_mfma_f32_16x16x32_bf16 v[160:163], a[216:219], v[24:27], v[160:163]
    v_mfma_f32_16x16x32_bf16 v[180:183], a[216:219], v[28:31], v[180:183]
    v_mfma_f32_16x16x32_bf16 v[124:127], a[220:223], v[16:19], v[124:127]
    s_waitcnt vmcnt(7)
    v_max_u32 v248, v32, v34
    v_mfma_f32_16x16x32_bf16 v[144:147], a[220:223], v[20:23], v[144:147]
    buffer_load_dwordx4 v[76:79], v231, s[36:39], s28 offen sc1
    v_max3_u32 v248, v36, v38, v248
    v_mfma_f32_16x16x32_bf16 v[164:167], a[220:223], v[24:27], v[164:167]
    v_max3_u32 v248, v40, v42, v248
    v_max3_u32 v248, v44, v46, v248
    v_mfma_f32_16x16x32_bf16 v[184:187], a[220:223], v[28:31], v[184:187]
    v_cmp_eq_u32 vcc, s92, v248
    v_mfma_f32_16x16x32_bf16 v[128:131], a[224:227], v[16:19], v[128:131]
    s_cbranch_vccnz L_mre9
L_mre9_ok:
    v_mfma_f32_16x16x32_bf16 v[148:151], a[224:227], v[20:23], v[148:151]
    v_mfma_f32_16x16x32_bf16 v[168:171], a[224:227], v[24:27], v[168:171]
    v_mfma_f32_16x16x32_bf16 v[188:191], a[224:227], v[28:31], v[188:191]
    v_mov_b32 v195, v221
    buffer_load_dwordx2 v[196:197], v194, s[36:39], 0 offen sc1
    v_mfma_f32_16x16x32_bf16 v[112:115], a[228:231], v[32:35], v[112:115]
    s_waitcnt vmcnt(5)
    v_max_u32 v248, v48, v50
    v_mfma_f32_16x16x32_bf16 v[116:119], a[232:235], v[32:35], v[116:119]
    v_max3_u32 v248, v52, v54, v248
    v_max3_u32 v248, v56, v58, v248
    v_mfma_f32_16x16x32_bf16 v[120:123], a[236:239], v[32:35], v[120:123]
    v_max3_u32 v248, v60, v62, v248
    v_cmp_eq_u32 vcc, s92, v248
    v_mfma_f32_16x16x32_bf16 v[124:127], a[240:243], v[32:35], v[124:127]
    s_cbranch_vccnz L_mre10
L_mre10_ok:
    v_mfma_f32_16x16x32_bf16 v[128:131], a[244:247], v[32:35], v[128:131]
    v_mfma_f32_16x16x32_bf16 v[112:115], a[0:3], v[48:51], v[112:115]
    s_waitcnt vmcnt(1)
    v_max_u32 v248, v64, v66
    v_mfma_f32_16x16x32_bf16 v[116:119], a[4:7], v[48:51], v[116:119]
    v_max3_u32 v248, v68, v70, v248
    v_max3_u32 v248, v72, v74, v248
    v_mfma_f32_16x16x32_bf16 v[120:123], a[8:11], v[48:51], v[120:123]
    v_max3_u32 v248, v76, v78, v248
    v_cmp_eq_u32 vcc, s92, v248
    v_mfma_f32_16x16x32_bf16 v[124:127], a[12:15], v[48:51], v[124:127]
    s_cbranch_vccnz L_mre11
L_mre11_ok:
    v_mfma_f32_16x16x32_bf16 v[128:131], a[16:19], v[48:51], v[128:131]
    v_mfma_f32_16x16x32_bf16 v[112:115], a[20:23], v[64:67], v[112:115]
    v_mfma_f32_16x16x32_bf16 v[116:119], a[24:27], v[64:67], v[116:119]
    v_mfma_f32_16x16x32_bf16 v[120:123], a[28:31], v[64:67], v[120:123]
    v_mfma_f32_16x16x32_bf16 v[124:127], a[32:35], v[64:67], v[124:127]
    v_mfma_f32_16x16x32_bf16 v[128:131], a[36:39], v[64:67], v[128:131]
    v_mfma_f32_16x16x32_bf16 v[132:135], a[228:231], v[36:39], v[132:135]
    v_mfma_f32_16x16x32_bf16 v[136:139], a[232:235], v[36:39], v[136:139]
    v_mfma_f32_16x16x32_bf16 v[140:143], a[236:239], v[36:39], v[140:143]
    v_mfma_f32_16x16x32_bf16 v[144:147], a[240:243], v[36:39], v[144:147]
    v_mfma_f32_16x16x32_bf16 v[148:151], a[244:247], v[36:39], v[148:151]
    ds_write_b128 v208, v[112:115] offset:0
    v_mfma_f32_16x16x32_bf16 v[132:135], a[0:3], v[52:55], v[132:135]
    v_mfma_f32_16x16x32_bf16 v[136:139], a[4:7], v[52:55], v[136:139]
    ds_write_b128 v208, v[116:119] offset:1024
    v_mfma_f32_16x16x32_bf16 v[140:143], a[8:11], v[52:55], v[140:143]
    v_mfma_f32_16x16x32_bf16 v[144:147], a[12:15], v[52:55], v[144:147]
    v_mfma_f32_16x16x32_bf16 v[148:151], a[16:19], v[52:55], v[148:151]
    ds_write_b128 v208, v[120:123] offset:2048
    v_mfma_f32_16x16x32_bf16 v[132:135], a[20:23], v[68:71], v[132:135]
    ds_write_b128 v208, v[124:127] offset:3072
    v_mfma_f32_16x16x32_bf16 v[136:139], a[24:27], v[68:71], v[136:139]
    v_mfma_f32_16x16x32_bf16 v[140:143], a[28:31], v[68:71], v[140:143]
    v_mfma_f32_16x16x32_bf16 v[144:147], a[32:35], v[68:71], v[144:147]
    ds_write_b128 v208, v[128:131] offset:4096
    v_mfma_f32_16x16x32_bf16 v[148:151], a[36:39], v[68:71], v[148:151]
    v_mfma_f32_16x16x32_bf16 v[152:155], a[228:231], v[40:43], v[152:155]
    s_waitcnt vmcnt(0)
    v_cmp_ne_u32 vcc, s60, v197
    v_mfma_f32_16x16x32_bf16 v[156:159], a[232:235], v[40:43], v[156:159]
    s_cbranch_vccnz L_r2
L_r2_ok:
    v_mfma_f32_16x16x32_bf16 v[160:163], a[236:239], v[40:43], v[160:163]
    v_lshlrev_b32 v0, 16, v198
    v_and_b32 v1, s93, v198
    v_mfma_f32_16x16x32_bf16 v[164:167], a[240:243], v[40:43], v[164:167]
    v_lshlrev_b32 v2, 16, v199
    v_and_b32 v3, s93, v199
    v_mfma_f32_16x16x32_bf16 v[168:171], a[244:247], v[40:43], v[168:171]
    ds_write_b128 v209, v[132:135] offset:0
    v_mfma_f32_16x16x32_bf16 v[152:155], a[0:3], v[56:59], v[152:155]
    v_lshlrev_b32 v4, 16, v200
    v_and_b32 v5, s93, v200
    v_mfma_f32_16x16x32_bf16 v[156:159], a[4:7], v[56:59], v[156:159]
    ds_write_b128 v209, v[136:139] offset:1024
    v_lshlrev_b32 v6, 16, v201
    v_mfma_f32_16x16x32_bf16 v[160:163], a[8:11], v[56:59], v[160:163]
    v_and_b32 v7, s93, v201
    v_lshlrev_b32 v8, 16, v202
    v_mfma_f32_16x16x32_bf16 v[164:167], a[12:15], v[56:59], v[164:167]
    v_and_b32 v9, s93, v202
    v_lshlrev_b32 v10, 16, v203
    v_mfma_f32_16x16x32_bf16 v[168:171], a[16:19], v[56:59], v[168:171]
    ds_write_b128 v209, v[140:143] offset:2048
    v_mfma_f32_16x16x32_bf16 v[152:155], a[20:23], v[72:75], v[152:155]
    ds_write_b128 v209, v[144:147] offset:3072
    v_and_b32 v11, s93, v203
    v_mfma_f32_16x16x32_bf16 v[156:159], a[24:27], v[72:75], v[156:159]
    v_lshlrev_b32 v12, 16, v204
    v_and_b32 v13, s93, v204
    v_mfma_f32_16x16x32_bf16 v[160:163], a[28:31], v[72:75], v[160:163]
    v_lshlrev_b32 v14, 16, v205
    v_and_b32 v15, s93, v205
    v_mfma_f32_16x16x32_bf16 v[164:167], a[32:35], v[72:75], v[164:167]
    ds_write_b128 v209, v[148:151] offset:4096
    v_lshlrev_b32 v16, 16, v206
    v_mfma_f32_16x16x32_bf16 v[168:171], a[36:39], v[72:75], v[168:171]
    v_and_b32 v17, s93, v206
    v_mfma_f32_16x16x32_bf16 v[172:175], a[228:231], v[44:47], v[172:175]
    v_lshlrev_b32 v18, 16, v207
    v_and_b32 v19, s93, v207
    v_mfma_f32_16x16x32_bf16 v[176:179], a[232:235], v[44:47], v[176:179]
    v_lshrrev_b32 v222, 4, v224
    v_and_b32 v223, 1, v222
    v_mfma_f32_16x16x32_bf16 v[180:183], a[236:239], v[44:47], v[180:183]
    v_lshrrev_b32 v193, 1, v222
    v_lshlrev_b32 v222, 3, v222
    v_mfma_f32_16x16x32_bf16 v[184:187], a[240:243], v[44:47], v[184:187]
    v_sub_u32 v222, v195, v222
    v_lshl_add_u32 v222, v223, 5, v222
    v_mfma_f32_16x16x32_bf16 v[188:191], a[244:247], v[44:47], v[188:191]
    ds_write_b128 v210, v[152:155] offset:0
    v_mfma_f32_16x16x32_bf16 v[172:175], a[0:3], v[60:63], v[172:175]
    v_lshl_add_u32 v222, v193, 4, v222
    v_mfma_f32_16x16x32_bf16 v[176:179], a[4:7], v[60:63], v[176:179]
    ds_write_b128 v210, v[156:159] offset:1024
    v_mfma_f32_16x16x32_bf16 v[180:183], a[8:11], v[60:63], v[180:183]
    v_mfma_f32_16x16x32_bf16 v[184:187], a[12:15], v[60:63], v[184:187]
    v_mfma_f32_16x16x32_bf16 v[188:191], a[16:19], v[60:63], v[188:191]
    ds_write_b128 v210, v[160:163] offset:2048
    v_mfma_f32_16x16x32_bf16 v[172:175], a[20:23], v[76:79], v[172:175]
    ds_write_b128 v210, v[164:167] offset:3072
    v_mfma_f32_16x16x32_bf16 v[176:179], a[24:27], v[76:79], v[176:179]
    v_mfma_f32_16x16x32_bf16 v[180:183], a[28:31], v[76:79], v[180:183]
    v_mfma_f32_16x16x32_bf16 v[184:187], a[32:35], v[76:79], v[184:187]
    ds_write_b128 v210, v[168:171] offset:4096
    v_mfma_f32_16x16x32_bf16 v[188:191], a[36:39], v[76:79], v[188:191]
    s_waitcnt lgkmcnt(0)
    s_barrier
    s_nop 0
    ds_read_b128 v[20:23], v211 offset:0
    ds_read_b128 v[24:27], v211 offset:5120
    ds_read_b128 v[28:31], v211 offset:10240
    ds_read_b128 v[32:35], v211 offset:1024
    ds_read_b128 v[36:39], v211 offset:6144
    ds_read_b128 v[40:43], v211 offset:11264
    ds_read_b128 v[44:47], v211 offset:2048
    ds_read_b128 v[48:51], v211 offset:7168
    ds_read_b128 v[52:55], v211 offset:12288
    ds_read_b128 v[56:59], v211 offset:3072
    ds_read_b128 v[60:63], v211 offset:8192
    ds_read_b128 v[64:67], v211 offset:13312
    ds_read_b128 v[68:71], v211 offset:4096
    ds_read_b128 v[72:75], v211 offset:9216
    ds_read_b128 v[76:79], v211 offset:14336
    s_waitcnt lgkmcnt(12)
    s_nop 0
    v_pk_add_f32 v[172:173], v[172:173], v[20:21]
    v_pk_add_f32 v[24:25], v[24:25], v[28:29]
    v_pk_add_f32 v[174:175], v[174:175], v[22:23]
    v_pk_add_f32 v[26:27], v[26:27], v[30:31]
    v_pk_add_f32 v[172:173], v[172:173], v[24:25]
    v_pk_add_f32 v[174:175], v[174:175], v[26:27]
    v_pk_fma_f32 v[0:1], v[172:173], v[196:197], v[0:1] op_sel_hi:[1,0,1]
    v_pk_fma_f32 v[2:3], v[174:175], v[196:197], v[2:3] op_sel_hi:[1,0,1]
    v_cvt_pk_bf16_f32 v212, v0, v1
    v_cvt_pk_bf16_f32 v213, v2, v3
    s_waitcnt lgkmcnt(9)
    s_nop 0
    v_pk_add_f32 v[176:177], v[176:177], v[32:33]
    v_pk_add_f32 v[36:37], v[36:37], v[40:41]
    v_pk_add_f32 v[178:179], v[178:179], v[34:35]
    v_pk_add_f32 v[38:39], v[38:39], v[42:43]
    v_pk_add_f32 v[176:177], v[176:177], v[36:37]
    v_pk_add_f32 v[178:179], v[178:179], v[38:39]
    v_pk_fma_f32 v[4:5], v[176:177], v[196:197], v[4:5] op_sel_hi:[1,0,1]
    v_pk_fma_f32 v[6:7], v[178:179], v[196:197], v[6:7] op_sel_hi:[1,0,1]
    v_cvt_pk_bf16_f32 v214, v4, v5
    v_cvt_pk_bf16_f32 v215, v6, v7
    s_nop 0
    v_permlane16_swap_b32 v212, v214
    v_permlane16_swap_b32 v213, v215
    buffer_store_dwordx4 v[212:215], v222, s[56:59], 0 offen offset:0
    s_waitcnt lgkmcnt(6)
    v_pk_add_f32 v[180:181], v[180:181], v[44:45]
    v_pk_add_f32 v[48:49], v[48:49], v[52:53]
    v_pk_add_f32 v[182:183], v[182:183], v[46:47]
    v_pk_add_f32 v[50:51], v[50:51], v[54:55]
    v_pk_add_f32 v[180:181], v[180:181], v[48:49]
    v_pk_add_f32 v[182:183], v[182:183], v[50:51]
    v_pk_fma_f32 v[8:9], v[180:181], v[196:197], v[8:9] op_sel_hi:[1,0,1]
    v_pk_fma_f32 v[10:11], v[182:183], v[196:197], v[10:11] op_sel_hi:[1,0,1]
    v_cvt_pk_bf16_f32 v216, v8, v9
    v_cvt_pk_bf16_f32 v217, v10, v11
    s_waitcnt lgkmcnt(3)
    s_nop 0
    v_pk_add_f32 v[184:185], v[184:185], v[56:57]
    v_pk_add_f32 v[60:61], v[60:61], v[64:65]
    v_pk_add_f32 v[186:187], v[186:187], v[58:59]
    v_pk_add_f32 v[62:63], v[62:63], v[66:67]
    v_pk_add_f32 v[184:185], v[184:185], v[60:61]
    v_pk_add_f32 v[186:187], v[186:187], v[62:63]
    v_pk_fma_f32 v[12:13], v[184:185], v[196:197], v[12:13] op_sel_hi:[1,0,1]
    v_pk_fma_f32 v[14:15], v[186:187], v[196:197], v[14:15] op_sel_hi:[1,0,1]
    v_cvt_pk_bf16_f32 v218, v12, v13
    v_cvt_pk_bf16_f32 v219, v14, v15
    s_nop 0
    v_permlane16_swap_b32 v216, v218
    v_permlane16_swap_b32 v217, v219
    buffer_store_dwordx4 v[216:219], v222, s[56:59], 0 offen offset:64
    s_waitcnt lgkmcnt(0)
    v_pk_add_f32 v[188:189], v[188:189], v[68:69]
    v_pk_add_f32 v[72:73], v[72:73], v[76:77]
    v_pk_add_f32 v[190:191], v[190:191], v[70:71]
    v_pk_add_f32 v[74:75], v[74:75], v[78:79]
    v_pk_add_f32 v[188:189], v[188:189], v[72:73]
    v_pk_add_f32 v[190:191], v[190:191], v[74:75]
    v_pk_fma_f32 v[16:17], v[188:189], v[196:197], v[16:17] op_sel_hi:[1,0,1]
    v_pk_fma_f32 v[18:19], v[190:191], v[196:197], v[18:19] op_sel_hi:[1,0,1]
    v_cvt_pk_bf16_f32 v220, v16, v17
    v_cvt_pk_bf16_f32 v221, v18, v19
    buffer_store_dwordx2 v[220:221], v195, s[56:59], 0 offen offset:128
    s_or_b32 s70, s2, s61
    s_cmp_eq_u32 s70, 0
    s_cbranch_scc0 L_nogen
    v_mov_b32 v10, 0
    v_mov_b32 v11, s60
    s_mov_b64 exec, 1
    buffer_store_dword v11, v10, s[36:39], 0 offen sc1
    s_mov_b64 exec, -1
L_nogen:
L_end:
    s_endpgm
L_sweep_again:
    s_add_u32 s65, s65, 1
    s_cmp_ge_u32 s65, 50000
    s_cbranch_scc1 L_swept
    buffer_load_dwordx4 v[110:113], v249, s[36:39], 0 offen offset:0 sc1
    buffer_load_dwordx4 v[114:117], v249, s[36:39], 0 offen offset:16 sc1
    buffer_load_dwordx4 v[118:121], v249, s[36:39], 0 offen offset:32 sc1
    buffer_load_dwordx4 v[122:125], v249, s[36:39], 0 offen offset:48 sc1
    buffer_load_dword v9, v253, s[36:39], 0 offen sc1
    s_branch L_sweep
L_fpoll1:
    s_add_u32 s65, s65, 1
    s_cmp_ge_u32 s65, 50000
    s_cbranch_scc1 L_fpolled1
    buffer_load_dword v10, v226, s[36:39], 0 offen sc1
    s_waitcnt vmcnt(0)
    v_cmp_ne_u32 vcc, s60, v10
    s_nop 0
    s_cbranch_vccnz L_fpoll1
    s_branch L_fpolled1
L_fpoll0:
    s_add_u32 s65, s65, 1
    s_cmp_ge_u32 s65, 50000
    s_cbranch_scc1 L_fpolled0
    buffer_load_dword v9, v254, s[36:39], 0 offen sc1
    s_waitcnt vmcnt(0)
    v_cmp_ne_u32 vcc, s60, v9
    s_nop 0
    s_cbranch_vccnz L_fpoll0
    s_branch L_fpolled0
L_pd:
    s_add_u32 s65, s65, 1
    s_cmp_ge_u32 s65, 50000
    s_cbranch_scc1 L_pd_ok
    s_sleep 2
    buffer_load_dword v8, v253, s[36:39], 0 offen sc1
    s_waitcnt vmcnt(0)
    v_cmp_ne_u32 vcc, s60, v8
    s_nop 0
    s_cbranch_vccnz L_pd
    s_branch L_pd_ok
L_pw:
    s_add_u32 s65, s65, 1
    s_cmp_ge_u32 s65, 50000
    s_cbranch_scc1 L_pw_ok
    s_sleep 2
    buffer_load_dword v7, v135, s[36:39], 0 offen sc1
    s_waitcnt vmcnt(0)
    v_cmp_ne_u32 vcc, s60, v7
    s_nop 0
    s_cbranch_vccnz L_pw
    s_branch L_pw_ok
L_ph:
    s_add_u32 s65, s65, 1
    s_cmp_ge_u32 s65, 50000
    s_cbranch_scc1 L_ph_ok
    s_sleep 2
    buffer_load_dword v9, v226, s[36:39], 0 offen sc1
    s_waitcnt vmcnt(0)
    v_cmp_ne_u32 vcc, s60, v9
    s_nop 0
    s_cbranch_vccnz L_ph
    s_branch L_ph_ok
L_hre0:
    s_add_u32 s65, s65, 1
    s_cmp_ge_u32 s65, 50000
    s_cbranch_scc1 L_hre0_ok
    s_sleep 8
    s_add_u32 s29, s40, 0
    s_nop 0
    buffer_load_dwordx4 v[0:3], v232, s[36:39], s29 offen sc1
    buffer_load_dwordx4 v[4:7], v233, s[36:39], s29 offen sc1
    s_add_u32 s29, s40, 131072
    buffer_load_dwordx4 v[8:11], v232, s[36:39], s29 offen sc1
    buffer_load_dwordx4 v[12:15], v233, s[36:39], s29 offen sc1
    s_waitcnt vmcnt(0)
    v_max_u32 v248, v0, v2
    v_max3_u32 v248, v4, v6, v248
    v_max3_u32 v248, v8, v10, v248
    v_max3_u32 v248, v12, v14, v248
    v_cmp_eq_u32 vcc, s92, v248
    s_nop 0
    s_cbranch_vccnz L_hre0
    s_branch L_hre0_ok
L_hre1:
    s_add_u32 s65, s65, 1
    s_cmp_ge_u32 s65, 50000
    s_cbranch_scc1 L_hre1_ok
    s_add_u32 s29, s40, 262144
    buffer_load_dwordx4 v[16:19], v232, s[36:39], s29 offen sc1
    buffer_load_dwordx4 v[20:23], v233, s[36:39], s29 offen sc1
    s_add_u32 s29, s40, 393216
    buffer_load_dwordx4 v[24:27], v232, s[36:39], s29 offen sc1
    buffer_load_dwordx4 v[28:31], v233, s[36:39], s29 offen sc1
    s_waitcnt vmcnt(0)
    v_max_u32 v248, v16, v18
    v_max3_u32 v248, v20, v22, v248
    v_max3_u32 v248, v24, v26, v248
    v_max3_u32 v248, v28, v30, v248
    v_cmp_eq_u32 vcc, s92, v248
    s_nop 0
    s_cbranch_vccnz L_hre1
    s_branch L_hre1_ok
L_hre2:
    s_add_u32 s65, s65, 1
    s_cmp_ge_u32 s65, 50000
    s_cbranch_scc1 L_hre2_ok
    s_add_u32 s29, s40, 524288
    buffer_load_dwordx4 v[32:35], v232, s[36:39], s29 offen sc1
    buffer_load_dwordx4 v[36:39], v233, s[36:39], s29 offen sc1
    s_add_u32 s29, s41, 0
    buffer_load_dwordx4 v[40:43], v232, s[36:39], s29 offen sc1
    buffer_load_dwordx4 v[44:47], v233, s[36:39], s29 offen sc1
    s_waitcnt vmcnt(0)
    v_max_u32 v248, v32, v34
    v_max3_u32 v248, v36, v38, v248
    v_max3_u32 v248, v40, v42, v248
    v_max3_u32 v248, v44, v46, v248
    v_cmp_eq_u32 vcc, s92, v248
    s_nop 0
    s_cbranch_vccnz L_hre2
    s_branch L_hre2_ok
L_hre3:
    s_add_u32 s65, s65, 1
    s_cmp_ge_u32 s65, 50000
    s_cbranch_scc1 L_hre3_ok
    s_nop 0
    s_add_u32 s29, s41, 131072
    buffer_load_dwordx4 v[48:51], v232, s[36:39], s29 offen sc1
    buffer_load_dwordx4 v[52:55], v233, s[36:39], s29 offen sc1
    s_add_u32 s29, s41, 262144
    buffer_load_dwordx4 v[56:59], v232, s[36:39], s29 offen sc1
    buffer_load_dwordx4 v[60:63], v233, s[36:39], s29 offen sc1
    s_waitcnt vmcnt(0)
    v_max_u32 v248, v48, v50
    v_max3_u32 v248, v52, v54, v248
    v_max3_u32 v248, v56, v58, v248
    v_max3_u32 v248, v60, v62, v248
    v_cmp_eq_u32 vcc, s92, v248
    s_nop 0
    s_cbranch_vccnz L_hre3
    s_branch L_hre3_ok
L_hre4:
    s_add_u32 s65, s65, 1
    s_cmp_ge_u32 s65, 50000
    s_cbranch_scc1 L_hre4_ok
    s_add_u32 s29, s41, 393216
    buffer_load_dwordx4 v[64:67], v232, s[36:39], s29 offen sc1
    buffer_load_dwordx4 v[68:71], v233, s[36:39], s29 offen sc1
    s_add_u32 s29, s41, 524288
    buffer_load_dwordx4 v[72:75], v232, s[36:39], s29 offen sc1
    buffer_load_dwordx4 v[76:79], v233, s[36:39], s29 offen sc1
    s_waitcnt vmcnt(0)
    v_max_u32 v248, v64, v66
    v_max3_u32 v248, v68, v70, v248
    v_max3_u32 v248, v72, v74, v248
    v_max3_u32 v248, v76, v78, v248
    v_cmp_eq_u32 vcc, s92, v248
    s_nop 0
    s_cbranch_vccnz L_hre4
    s_branch L_hre4_ok
L_l2re:
    s_add_u32 s65, s65, 1
    s_cmp_ge_u32 s65, 50000
    s_cbranch_scc1 L_l2re_ok
    buffer_load_dwordx4 v[240:243], v236, s[36:39], 0 offen sc1
    buffer_load_dwordx4 v[244:247], v237, s[36:39], 0 offen sc1
    buffer_load_dwordx4 v[252:255], v238, s[36:39], 0 offen sc1
    s_waitcnt vmcnt(0)
    v_max_u32 v248, v240, v242
    v_max3_u32 v248, v244, v246, v248
    v_max3_u32 v248, v252, v254, v248
    v_cmp_eq_u32 vcc, s92, v248
    s_nop 0
    s_cbranch_vccnz L_l2re
    s_branch L_l2re_ok
L_hre5:
    s_add_u32 s65, s65, 1
    s_cmp_ge_u32 s65, 50000
    s_cbranch_scc1 L_hre5_ok
    s_add_u32 s29, s42, 0
    s_nop 0
    buffer_load_dwordx4 v[80:83], v232, s[36:39], s29 offen sc1
    buffer_load_dwordx4 v[84:87], v233, s[36:39], s29 offen sc1
    s_add_u32 s29, s42, 131072
    buffer_load_dwordx4 v[88:91], v232, s[36:39], s29 offen sc1
    buffer_load_dwordx4 v[92:95], v233, s[36:39], s29 offen sc1
    s_waitcnt vmcnt(0)
    v_max_u32 v248, v80, v82
    v_max3_u32 v248, v84, v86, v248
    v_max3_u32 v248, v88, v90, v248
    v_max3_u32 v248, v92, v94, v248
    v_cmp_eq_u32 vcc, s92, v248
    s_nop 0
    s_cbranch_vccnz L_hre5
    s_branch L_hre5_ok
L_hre6:
    s_add_u32 s65, s65, 1
    s_cmp_ge_u32 s65, 50000
    s_cbranch_scc1 L_hre6_ok
    s_add_u32 s29, s42, 262144
    buffer_load_dwordx4 v[96:99], v232, s[36:39], s29 offen sc1
    buffer_load_dwordx4 v[100:103], v233, s[36:39], s29 offen sc1
    s_add_u32 s29, s42, 393216
    buffer_load_dwordx4 v[104:107], v232, s[36:39], s29 offen sc1
    buffer_load_dwordx4 v[108:111], v233, s[36:39], s29 offen sc1
    s_waitcnt vmcnt(0)
    v_max_u32 v248, v96, v98
    v_max3_u32 v248, v100, v102, v248
    v_max3_u32 v248, v104, v106, v248
    v_max3_u32 v248, v108, v110, v248
    v_cmp_eq_u32 vcc, s92, v248
    s_nop 0
    s_cbranch_vccnz L_hre6
    s_branch L_hre6_ok
L_hre7:
    s_add_u32 s65, s65, 1
    s_cmp_ge_u32 s65, 50000
    s_cbranch_scc1 L_hre7_ok
    s_add_u32 s29, s42, 524288
    buffer_load_dwordx4 v[112:115], v232, s[36:39], s29 offen sc1
    buffer_load_dwordx4 v[116:119], v233, s[36:39], s29 offen sc1
    s_add_u32 s29, s43, 0
    buffer_load_dwordx4 v[120:123], v232, s[36:39], s29 offen sc1
    buffer_load_dwordx4 v[124:127], v233, s[36:39], s29 offen sc1
    s_waitcnt vmcnt(0)
    v_max_u32 v248, v112, v114
    v_max3_u32 v248, v116, v118, v248
    v_max3_u32 v248, v120, v122, v248
    v_max3_u32 v248, v124, v126, v248
    v_cmp_eq_u32 vcc, s92, v248
    s_nop 0
    s_cbranch_vccnz L_hre7
    s_branch L_hre7_ok
L_hre8:
    s_add_u32 s65, s65, 1
    s_cmp_ge_u32 s65, 50000
    s_cbranch_scc1 L_hre8_ok
    s_nop 0
    s_add_u32 s29, s43, 131072
    buffer_load_dwordx4 v[128:131], v232, s[36:39], s29 offen sc1
    buffer_load_dwordx4 v[132:135], v233, s[36:39], s29 offen sc1
    s_add_u32 s29, s43, 262144
    buffer_load_dwordx4 v[136:139], v232, s[36:39], s29 offen sc1
    buffer_load_dwordx4 v[140:143], v233, s[36:39], s29 offen sc1
    s_waitcnt vmcnt(0)
    v_max_u32 v248, v128, v130
    v_max3_u32 v248, v132, v134, v248
    v_max3_u32 v248, v136, v138, v248
    v_max3_u32 v248, v140, v142, v248
    v_cmp_eq_u32 vcc, s92, v248
    s_nop 0
    s_cbranch_vccnz L_hre8
    s_branch L_hre8_ok
L_hre9:
    s_add_u32 s65, s65, 1
    s_cmp_ge_u32 s65, 50000
    s_cbranch_scc1 L_hre9_ok
    s_add_u32 s29, s43, 393216
    buffer_load_dwordx4 v[144:147], v232, s[36:39], s29 offen sc1
    buffer_load_dwordx4 v[148:151], v233, s[36:39], s29 offen sc1
    s_add_u32 s29, s43, 524288
    buffer_load_dwordx4 v[152:155], v232, s[36:39], s29 offen sc1
    buffer_load_dwordx4 v[156:159], v233, s[36:39], s29 offen sc1
    s_waitcnt vmcnt(0)
    v_max_u32 v248, v144, v146
    v_max3_u32 v248, v148, v150, v248
    v_max3_u32 v248, v152, v154, v248
    v_max3_u32 v248, v156, v158, v248
    v_cmp_eq_u32 vcc, s92, v248
    s_nop 0
    s_cbranch_vccnz L_hre9
    s_branch L_hre9_ok
L_fp:
    s_add_u32 s65, s65, 1
    s_cmp_ge_u32 s65, 50000
    s_cbranch_scc1 L_fp_ok
    buffer_load_dword v255, v226, s[36:39], 0 offen sc1
    s_waitcnt vmcnt(0)
    v_cmp_ne_u32 vcc, s60, v255
    s_nop 0
    s_cbranch_vccnz L_fp
    s_branch L_fp_ok
L_mre0:
    s_add_u32 s65, s65, 1
    s_cmp_ge_u32 s65, 50000
    s_cbranch_scc1 L_mre0_ok
    s_add_u32 s29, s52, 0
    buffer_load_dwordx4 v[0:3], v228, s[36:39], s29 offen sc1
    buffer_load_dwordx4 v[4:7], v229, s[36:39], s29 offen sc1
    buffer_load_dwordx4 v[8:11], v230, s[36:39], s29 offen sc1
    buffer_load_dwordx4 v[12:15], v231, s[36:39], s29 offen sc1
    s_waitcnt vmcnt(0)
    v_max_u32 v248, v0, v2
    v_max3_u32 v248, v4, v6, v248
    v_max3_u32 v248, v8, v10, v248
    v_max3_u32 v248, v12, v14, v248
    v_cmp_eq_u32 vcc, s92, v248
    s_nop 0
    s_cbranch_vccnz L_mre0
    s_branch L_mre0_ok
L_mre1:
    s_add_u32 s65, s65, 1
    s_cmp_ge_u32 s65, 50000
    s_cbranch_scc1 L_mre1_ok
    s_add_u32 s29, s53, 0
    buffer_load_dwordx4 v[16:19], v228, s[36:39], s29 offen sc1
    buffer_load_dwordx4 v[20:23], v229, s[36:39], s29 offen sc1
    buffer_load_dwordx4 v[24:27], v230, s[36:39], s29 offen sc1
    buffer_load_dwordx4 v[28:31], v231, s[36:39], s29 offen sc1
    s_waitcnt vmcnt(0)
    v_max_u32 v248, v16, v18
    v_max3_u32 v248, v20, v22, v248
    v_max3_u32 v248, v24, v26, v248
    v_max3_u32 v248, v28, v30, v248
    v_cmp_eq_u32 vcc, s92, v248
    s_nop 0
    s_cbranch_vccnz L_mre1
    s_branch L_mre1_ok
L_mre2:
    s_add_u32 s65, s65, 1
    s_cmp_ge_u32 s65, 50000
    s_cbranch_scc1 L_mre2_ok
    s_add_u32 s29, s54, 0
    buffer_load_dwordx4 v[32:35], v228, s[36:39], s29 offen sc1
    buffer_load_dwordx4 v[36:39], v229, s[36:39], s29 offen sc1
    buffer_load_dwordx4 v[40:43], v230, s[36:39], s29 offen sc1
    buffer_load_dwordx4 v[44:47], v231, s[36:39], s29 offen sc1
    s_waitcnt vmcnt(0)
    v_max_u32 v248, v32, v34
    v_max3_u32 v248, v36, v38, v248
    v_max3_u32 v248, v40, v42, v248
    v_max3_u32 v248, v44, v46, v248
    v_cmp_eq_u32 vcc, s92, v248
    s_nop 0
    s_cbranch_vccnz L_mre2
    s_branch L_mre2_ok
L_mre3:
    s_add_u32 s65, s65, 1
    s_cmp_ge_u32 s65, 50000
    s_cbranch_scc1 L_mre3_ok
    s_add_u32 s29, s55, 0
    buffer_load_dwordx4 v[48:51], v228, s[36:39], s29 offen sc1
    buffer_load_dwordx4 v[52:55], v229, s[36:39], s29 offen sc1
    buffer_load_dwordx4 v[56:59], v230, s[36:39], s29 offen sc1
    buffer_load_dwordx4 v[60:63], v231, s[36:39], s29 offen sc1
    s_waitcnt vmcnt(0)
    v_max_u32 v248, v48, v50
    v_max3_u32 v248, v52, v54, v248
    v_max3_u32 v248, v56, v58, v248
    v_max3_u32 v248, v60, v62, v248
    v_cmp_eq_u32 vcc, s92, v248
    s_nop 0
    s_cbranch_vccnz L_mre3
    s_branch L_mre3_ok
L_mre4:
    s_add_u32 s65, s65, 1
    s_cmp_ge_u32 s65, 50000
    s_cbranch_scc1 L_mre4_ok
    s_nop 0
    s_add_u32 s29, s52, 16384
    buffer_load_dwordx4 v[64:67], v228, s[36:39], s29 offen sc1
    buffer_load_dwordx4 v[68:71], v229, s[36:39], s29 offen sc1
    buffer_load_dwordx4 v[72:75], v230, s[36:39], s29 offen sc1
    buffer_load_dwordx4 v[76:79], v231, s[36:39], s29 offen sc1
    s_waitcnt vmcnt(0)
    v_max_u32 v248, v64, v66
    v_max3_u32 v248, v68, v70, v248
    v_max3_u32 v248, v72, v74, v248
    v_max3_u32 v248, v76, v78, v248
    v_cmp_eq_u32 vcc, s92, v248
    s_nop 0
    s_cbranch_vccnz L_mre4
    s_branch L_mre4_ok
L_mre5:
    s_add_u32 s65, s65, 1
    s_cmp_ge_u32 s65, 50000
    s_cbranch_scc1 L_mre5_ok
    s_add_u32 s29, s53, 16384
    buffer_load_dwordx4 v[80:83], v228, s[36:39], s29 offen sc1
    buffer_load_dwordx4 v[84:87], v229, s[36:39], s29 offen sc1
    buffer_load_dwordx4 v[88:91], v230, s[36:39], s29 offen sc1
    buffer_load_dwordx4 v[92:95], v231, s[36:39], s29 offen sc1
    s_waitcnt vmcnt(0)
    v_max_u32 v248, v80, v82
    v_max3_u32 v248, v84, v86, v248
    v_max3_u32 v248, v88, v90, v248
    v_max3_u32 v248, v92, v94, v248
    v_cmp_eq_u32 vcc, s92, v248
    s_nop 0
    s_cbranch_vccnz L_mre5
    s_branch L_mre5_ok
L_mre6:
    s_add_u32 s65, s65, 1
    s_cmp_ge_u32 s65, 50000
    s_cbranch_scc1 L_mre6_ok
    s_add_u32 s29, s54, 16384
    buffer_load_dwordx4 v[96:99], v228, s[36:39], s29 offen sc1
    buffer_load_dwordx4 v[100:103], v229, s[36:39], s29 offen sc1
    buffer_load_dwordx4 v[104:107], v230, s[36:39], s29 offen sc1
    buffer_load_dwordx4 v[108:111], v231, s[36:39], s29 offen sc1
    s_waitcnt vmcnt(0)
    v_max_u32 v248, v96, v98
    v_max3_u32 v248, v100, v102, v248
    v_max3_u32 v248, v104, v106, v248
    v_max3_u32 v248, v108, v110, v248
    v_cmp_eq_u32 vcc, s92, v248
    s_nop 0
    s_cbranch_vccnz L_mre6
    s_branch L_mre6_ok
L_mre7:
    s_add_u32 s65, s65, 1
    s_cmp_ge_u32 s65, 50000
    s_cbranch_scc1 L_mre7_ok
    s_add_u32 s29, s55, 16384
    buffer_load_dwordx4 v[0:3], v228, s[36:39], s29 offen sc1
    buffer_load_dwordx4 v[4:7], v229, s[36:39], s29 offen sc1
    buffer_load_dwordx4 v[8:11], v230, s[36:39], s29 offen sc1
    buffer_load_dwordx4 v[12:15], v231, s[36:39], s29 offen sc1
    s_waitcnt vmcnt(0)
    v_max_u32 v248, v0, v2
    v_max3_u32 v248, v4, v6, v248
    v_max3_u32 v248, v8, v10, v248
    v_max3_u32 v248, v12, v14, v248
    v_cmp_eq_u32 vcc, s92, v248
    s_nop 0
    s_cbranch_vccnz L_mre7
    s_branch L_mre7_ok
L_mre8:
    s_add_u32 s65, s65, 1
    s_cmp_ge_u32 s65, 50000
    s_cbranch_scc1 L_mre8_ok
    s_add_u32 s29, s52, 32768
    buffer_load_dwordx4 v[16:19], v228, s[36:39], s29 offen sc1
    buffer_load_dwordx4 v[20:23], v229, s[36:39], s29 offen sc1
    buffer_load_dwordx4 v[24:27], v230, s[36:39], s29 offen sc1
    buffer_load_dwordx4 v[28:31], v231, s[36:39], s29 offen sc1
    s_waitcnt vmcnt(0)
    v_max_u32 v248, v16, v18
    v_max3_u32 v248, v20, v22, v248
    v_max3_u32 v248, v24, v26, v248
    v_max3_u32 v248, v28, v30, v248
    v_cmp_eq_u32 vcc, s92, v248
    s_nop 0
    s_cbranch_vccnz L_mre8
    s_branch L_mre8_ok
L_mre9:
    s_add_u32 s65, s65, 1
    s_cmp_ge_u32 s65, 50000
    s_cbranch_scc1 L_mre9_ok
    s_add_u32 s29, s53, 32768
    buffer_load_dwordx4 v[32:35], v228, s[36:39], s29 offen sc1
    buffer_load_dwordx4 v[36:39], v229, s[36:39], s29 offen sc1
    buffer_load_dwordx4 v[40:43], v230, s[36:39], s29 offen sc1
    buffer_load_dwordx4 v[44:47], v231, s[36:39], s29 offen sc1
    s_waitcnt vmcnt(0)
    v_max_u32 v248, v32, v34
    v_max3_u32 v248, v36, v38, v248
    v_max3_u32 v248, v40, v42, v248
    v_max3_u32 v248, v44, v46, v248
    v_cmp_eq_u32 vcc, s92, v248
    s_nop 0
    s_cbranch_vccnz L_mre9
    s_branch L_mre9_ok
L_mre10:
    s_add_u32 s65, s65, 1
    s_cmp_ge_u32 s65, 50000
    s_cbranch_scc1 L_mre10_ok
    s_add_u32 s29, s54, 32768
    buffer_load_dwordx4 v[48:51], v228, s[36:39], s29 offen sc1
    buffer_load_dwordx4 v[52:55], v229, s[36:39], s29 offen sc1
    buffer_load_dwordx4 v[56:59], v230, s[36:39], s29 offen sc1
    buffer_load_dwordx4 v[60:63], v231, s[36:39], s29 offen sc1
    s_waitcnt vmcnt(0)
    v_max_u32 v248, v48, v50
    v_max3_u32 v248, v52, v54, v248
    v_max3_u32 v248, v56, v58, v248
    v_max3_u32 v248, v60, v62, v248
    v_cmp_eq_u32 vcc, s92, v248
    s_nop 0
    s_cbranch_vccnz L_mre10
    s_branch L_mre10_ok
L_mre11:
    s_add_u32 s65, s65, 1
    s_cmp_ge_u32 s65, 50000
    s_cbranch_scc1 L_mre11_ok
    s_add_u32 s29, s55, 32768
    buffer_load_dwordx4 v[64:67], v228, s[36:39], s29 offen sc1
    buffer_load_dwordx4 v[68:71], v229, s[36:39], s29 offen sc1
    buffer_load_dwordx4 v[72:75], v230, s[36:39], s29 offen sc1
    buffer_load_dwordx4 v[76:79], v231, s[36:39], s29 offen sc1
    s_waitcnt vmcnt(0)
    v_max_u32 v248, v64, v66
    v_max3_u32 v248, v68, v70, v248
    v_max3_u32 v248, v72, v74, v248
    v_max3_u32 v248, v76, v78, v248
    v_cmp_eq_u32 vcc, s92, v248
    s_nop 0
    s_cbranch_vccnz L_mre11
    s_branch L_mre11_ok
L_r2:
    s_add_u32 s65, s65, 1
    s_cmp_ge_u32 s65, 50000
    s_cbranch_scc1 L_r2_ok
    buffer_load_dwordx2 v[196:197], v194, s[36:39], 0 offen sc1
    s_waitcnt vmcnt(0)
    v_cmp_ne_u32 vcc, s60, v197
    s_nop 0
    s_cbranch_vccnz L_r2
    s_branch L_r2_ok
L_code_end:
.section .rodata,"a"
.p2align 6
.amdhsa_kernel sequential_preLN__ssm_conv_s4d__glu_gated_bilinear__prompt_kernel
  .amdhsa_next_free_vgpr 512
  .amdhsa_next_free_sgpr 102
  .amdhsa_accum_offset 256
  .amdhsa_group_segment_fixed_size 0
  .amdhsa_kernarg_size 112
  .amdhsa_user_sgpr_count 2
  .amdhsa_user_sgpr_kernarg_segment_ptr 1
  .amdhsa_system_sgpr_workgroup_id_x 1
.end_amdhsa_kernel
```
